```python
import torch

def _softmax(x, axis=-1):
    return torch.softmax(x, dim=axis)
def _gelu(x):
    return torch.nn.functional.gelu(x, approximate="tanh")
def _silu(x):
    return torch.nn.functional.silu(x)
def _sigmoid(x):
    return torch.sigmoid(x)
def _layernorm(x, axis=-1, eps=1e-5):
    m = x.mean(dim=axis, keepdim=True)
    v = x.var(dim=axis, keepdim=True, unbiased=False)
    return (x - m) / torch.sqrt(v + eps)
def _scatter_add(tgt, idx, src, axis=0):
    return tgt.clone().index_add_(axis, idx, src)
def _segment_sum(src, seg, n):
    out = torch.zeros((n,) + src.shape[1:], dtype=src.dtype)
    return out.index_add_(0, seg, src)
def _pad(x, pw):
    flat = tuple(v for pair in reversed(pw) for v in pair)
    return torch.nn.functional.pad(x, flat)

kernel_name = 'parallel_sum__spectral_gfnet__mixer_token_mlp__prompt'

def setup_inputs():

    _w = (lambda a: (lambda t: t.to(torch.bfloat16) if t.is_floating_point() else t)(torch.as_tensor(a)))
    def _A_setup():
        B, S, D = 1, 2048, 1024
        Df = D // 2 + 1
        return {
            "x": _w((lambda *s: torch.randn(*s, dtype=torch.bfloat16) * 0.05)(B, S, D)),
            "w_r": _w((lambda *s: torch.randn(*s, dtype=torch.bfloat16) * 1.6)(S, Df) * 0.02),
            "w_i": _w((lambda *s: torch.randn(*s, dtype=torch.bfloat16) * 1.6)(S, Df) * 0.02),
        }
    _A_in = _A_setup()

    def _B_setup():
        B, S, D, F = 1, 2048, 1024, 3584
        return {
            "x": _w((lambda *s: torch.randn(*s, dtype=torch.bfloat16) * 0.05)(B, S, D)),
            "w1": _w((lambda *s: torch.randn(*s, dtype=torch.bfloat16) * 0.4)(S, F) * (S ** -0.5)),
            "b1": _w((lambda *s: torch.randn(*s, dtype=torch.bfloat16) * 3.2)(F) * 0.02),
            "w2": _w((lambda *s: torch.randn(*s, dtype=torch.bfloat16) * 0.8)(F, S) * (F ** -0.5)),
            "b2": _w((lambda *s: torch.randn(*s, dtype=torch.bfloat16) * 3.2)(S) * 0.02),
        }
    _B_in = _B_setup()

    return {
        "A_x": _A_in["x"],
        "A_w_r": _A_in["w_r"],
        "A_w_i": _A_in["w_i"],
        "B_x": _B_in["x"],
        "B_w1": _B_in["w1"],
        "B_b1": _B_in["b1"],
        "B_w2": _B_in["w2"],
        "B_b2": _B_in["b2"],
    }

def reference(A_x, A_w_r, A_w_i, B_x, B_w1, B_b1, B_w2, B_b2):
    def _A_ref(x, w_r, w_i):
        B, S, D = x.shape
        X = (lambda x, axes=(-2,-1): torch.fft.rfft2(x.float(), dim=axes))(x, axes=(-2, -1))
        W = w_r + 1j * w_i
        X = X * W
        y = (lambda x, s, axes=(-2,-1): torch.fft.irfft2(x, s=s, dim=axes).to(torch.bfloat16))(X, (S, D), axes=(-2, -1))
        return y

    def _B_ref(x, w1, b1, w2, b2):
        B, S, D = x.shape
        h = _layernorm(x, axis=-1)
        u = torch.einsum("bsd,sf->bdf", h, w1) + b1
        u = _gelu(u)
        y = torch.einsum("bdf,fs->bds", u, w2) + b2
        return (lambda x, *d: x.permute(*d))(y, 0, 2, 1)

    x = A_x
    xn = _layernorm(x, axis=-1)
    return x + _A_ref(xn, A_w_r, A_w_i) + _B_ref(xn, B_w1, B_b1, B_w2, B_b2)
```

```asm
; @launch kernel=gf_kernel grid=(256,1,1) block=(512,1,1) lds=141376
.amdgcn_target "amdgcn-amd-amdhsa--gfx950"
.text
.globl gf_kernel
.p2align 8
.type gf_kernel,@function
gf_kernel:
    s_cmp_ge_u32 s2, 256
    s_cbranch_scc1 L_end_1
    s_load_dwordx4 s[12:15], s[0:1], 0
    s_load_dwordx2 s[16:17], s[0:1], 16
    s_load_dwordx2 s[18:19], s[0:1], 80
    s_load_dwordx8 s[4:11], s[0:1], 32
    s_load_dwordx4 s[20:23], s[0:1], 64
    v_lshrrev_b32 v2, 6, v0
    s_and_b32 s29, s2, 7
    s_lshr_b32 s30, s2, 3
    v_readfirstlane_b32 s28, v2
    v_and_b32 v3, 15, v0
    v_lshlrev_b32 v3, 2, v3
    v_add_u32 v3, 141312, v3
    v_mov_b32 v4, 0
    ds_write_b32 v3, v4
    s_lshl_b32 s58, s30, 3
    s_add_u32 s58, s58, s28
    s_cmp_ge_u32 s58, 40
    s_cbranch_scc1 L_cp_6
    s_cmp_lg_u32 s28, 0
    s_cbranch_scc1 L_cp_6
    s_getpc_b64 s[44:45]
L_cp_6p:
    s_sub_u32 s44, s44, L_cp_6p-gf_kernel
    s_subb_u32 s45, s45, 0
    s_mov_b32 s46, gf_kernel_end-gf_kernel
    s_mov_b32 s47, 0x00020000
    s_lshl_b32 s58, s30, 13
    v_and_b32 v253, 63, v0
    v_lshlrev_b32 v253, 7, v253
    buffer_load_dword v253, v253, s[44:47], s58 offen
L_cp_6:
L_k1_7:
    v_and_b32 v1, 63, v0
    v_lshlrev_b32 v2, 4, v1
    s_lshr_b32 s89, s2, 3
    s_bfe_u32 s88, s2, 0x10002
    s_lshl_b32 s88, s88, 5
    s_add_u32 s89, s89, s88
    s_and_b32 s88, s2, 3
    s_lshl_b32 s88, s88, 8
    s_add_u32 s89, s89, s88
    s_and_b32 s88, s28, 3
    s_lshl_b32 s88, s88, 6
    s_add_u32 s89, s89, s88
    s_lshr_b32 s88, s28, 2
    s_lshl_b32 s88, s88, 10
    s_add_u32 s89, s89, s88
    s_lshl_b32 s89, s89, 11
    v_mov_b32 v40, 0
    s_cmp_ge_u32 s28, 4
    s_cbranch_scc1 L_pre_174
    v_and_b32 v110, 31, v1
    v_lshrrev_b32 v111, 5, v1
    v_cvt_f32_u32 v110, v110
    v_cvt_f32_u32 v111, v111
    v_mul_f32 v3, v110, v111
    v_mul_f32 v3, 0x3e000000, v3
    v_fmamk_f32 v80, v110, 0x00000000, v3
    v_fmamk_f32 v81, v110, 0x3d000000, v3
    v_fmamk_f32 v82, v110, 0x3d800000, v3
    v_fmamk_f32 v83, v110, 0x3dc00000, v3
    v_fmamk_f32 v84, v110, 0x3e800000, v3
    v_fmamk_f32 v85, v110, 0x3e900000, v3
    v_fmamk_f32 v86, v110, 0x3ea00000, v3
    v_fmamk_f32 v87, v110, 0x3eb00000, v3
    v_fmamk_f32 v88, v110, 0x3f000000, v3
    v_fmamk_f32 v89, v110, 0x3f080000, v3
    v_fmamk_f32 v90, v110, 0x3f100000, v3
    v_fmamk_f32 v91, v110, 0x3f180000, v3
    v_fmamk_f32 v92, v110, 0x3f400000, v3
    v_fmamk_f32 v93, v110, 0x3f480000, v3
    v_fmamk_f32 v94, v110, 0x3f500000, v3
    v_fmamk_f32 v95, v110, 0x3f580000, v3
    v_cos_f32 v64, v80
    v_sin_f32 v80, v80
    v_cos_f32 v65, v81
    v_sin_f32 v81, v81
    v_cos_f32 v66, v82
    v_sin_f32 v82, v82
    v_cos_f32 v67, v83
    v_sin_f32 v83, v83
    v_cos_f32 v68, v84
    v_sin_f32 v84, v84
    v_cos_f32 v69, v85
    v_sin_f32 v85, v85
    v_cos_f32 v70, v86
    v_sin_f32 v86, v86
    v_cos_f32 v71, v87
    v_sin_f32 v87, v87
    v_cos_f32 v72, v88
    v_sin_f32 v88, v88
    v_cos_f32 v73, v89
    v_sin_f32 v89, v89
    v_cos_f32 v74, v90
    v_sin_f32 v90, v90
    v_cos_f32 v75, v91
    v_sin_f32 v91, v91
    v_cos_f32 v76, v92
    v_sin_f32 v92, v92
    v_cos_f32 v77, v93
    v_sin_f32 v93, v93
    v_cos_f32 v78, v94
    v_sin_f32 v94, v94
    v_cos_f32 v79, v95
    v_sin_f32 v95, v95
    v_cvt_pk_bf16_f32 v40, v64, v65
    v_cvt_pk_bf16_f32 v41, v66, v67
    v_cvt_pk_bf16_f32 v42, v68, v69
    v_cvt_pk_bf16_f32 v43, v70, v71
    v_cvt_pk_bf16_f32 v44, v72, v73
    v_cvt_pk_bf16_f32 v45, v74, v75
    v_cvt_pk_bf16_f32 v46, v76, v77
    v_cvt_pk_bf16_f32 v47, v78, v79
    v_cvt_pk_bf16_f32 v48, v80, v81
    v_cvt_pk_bf16_f32 v49, v82, v83
    v_cvt_pk_bf16_f32 v50, v84, v85
    v_cvt_pk_bf16_f32 v51, v86, v87
    v_cvt_pk_bf16_f32 v52, v88, v89
    v_cvt_pk_bf16_f32 v53, v90, v91
    v_cvt_pk_bf16_f32 v54, v92, v93
    v_cvt_pk_bf16_f32 v55, v94, v95
    v_xor_b32 v56, 0x80008000, v48
    v_xor_b32 v57, 0x80008000, v49
    v_xor_b32 v58, 0x80008000, v50
    v_xor_b32 v59, 0x80008000, v51
    v_xor_b32 v60, 0x80008000, v52
    v_xor_b32 v61, 0x80008000, v53
    v_xor_b32 v62, 0x80008000, v54
    v_xor_b32 v63, 0x80008000, v55
L_pre_174:
    s_waitcnt lgkmcnt(0)
    s_add_u32 s24, s18, 0x4000000
    s_addc_u32 s25, s19, 0
    s_mov_b32 s26, 0x34000
    s_mov_b32 s27, 0x00020000
    s_mov_b32 s48, s22
    s_mov_b32 s49, s23
    s_mov_b32 s50, 0x100
    s_mov_b32 s51, 0x00020000
    v_mov_b32 v24, 196608
    v_mov_b32 v25, 1
    s_lshl_b32 s58, s2, 3
    s_add_u32 s58, s58, s28
    s_cmp_lg_u32 s58, 4
    s_cbranch_scc1 L_ep_175
    s_mov_b64 exec, 1
    buffer_atomic_add v25, v24, s[24:27], 0 offen sc0 sc1
    s_mov_b64 exec, -1
L_ep_175:
    s_mov_b32 s76, s12
    s_mov_b32 s77, s13
    s_mov_b32 s78, 0x400000
    s_mov_b32 s79, 0x00020000
    buffer_load_dwordx4 v[96:99], v2, s[76:79], s89 offen
    buffer_load_dwordx4 v[100:103], v2, s[76:79], s89 offen offset:1024
    s_cmp_lt_u32 s28, 4
    s_cbranch_scc1 L_consts_170
    s_and_b32 s58, s29, 1
    s_lshl_b32 s58, s58, 2
    s_and_b32 s57, s30, 3
    s_add_u32 s57, s57, s58
    s_lshl_b32 s57, s57, 11
    s_lshr_b32 s58, s29, 1
    s_mul_i32 s58, s58, 7
    s_lshr_b32 s56, s30, 2
    s_add_u32 s56, s56, s58
    s_lshl_b32 s56, s56, 8
    s_and_b32 s70, s28, 3
    s_and_b32 s58, s30, 3
    s_mul_i32 s62, s58, 1
    s_lshr_b32 s58, s30, 2
    s_mul_i32 s58, s58, 1
    s_add_u32 s62, s62, s58
    s_and_b32 s58, s29, 1
    s_mul_i32 s58, s58, 0
    s_add_u32 s62, s62, s58
    s_and_b32 s62, s62, 3
    v_lshrrev_b32 v28, 4, v1
    v_and_b32 v29, 15, v1
    v_lshlrev_b32 v30, 2, v28
    v_xor_b32 v29, v29, v30
    v_lshlrev_b32 v29, 4, v29
    s_lshr_b32 s58, s70, 1
    s_lshl_b32 s58, s58, 5
    v_lshl_add_u32 v32, v28, 6, s58
    s_and_b32 s58, s70, 1
    s_lshl_b32 s58, s58, 9
    s_add_u32 s58, s58, 0
    v_add_u32 v32, s58, v32
    v_mul_u32_u24 v32, 7168, v32
    v_add3_u32 v32, v32, v29, s56
    s_lshr_b32 s58, s70, 1
    s_lshl_b32 s58, s58, 5
    v_lshl_add_u32 v33, v28, 6, s58
    s_and_b32 s58, s70, 1
    s_lshl_b32 s58, s58, 9
    s_add_u32 s58, s58, 1024
    v_add_u32 v33, s58, v33
    v_mul_u32_u24 v33, 7168, v33
    v_add3_u32 v33, v33, v29, s56
    v_subrev_u32 v33, 1024, v33
    s_lshr_b32 s58, s70, 1
    s_lshl_b32 s58, s58, 5
    v_lshl_add_u32 v34, v28, 6, s58
    s_and_b32 s58, s70, 1
    s_lshl_b32 s58, s58, 9
    s_add_u32 s58, s58, 256
    v_add_u32 v34, s58, v34
    v_mul_u32_u24 v34, 7168, v34
    v_add3_u32 v34, v34, v29, s56
    v_subrev_u32 v34, 2048, v34
    s_lshr_b32 s58, s70, 1
    s_lshl_b32 s58, s58, 5
    v_lshl_add_u32 v35, v28, 6, s58
    s_and_b32 s58, s70, 1
    s_lshl_b32 s58, s58, 9
    s_add_u32 s58, s58, 1280
    v_add_u32 v35, s58, v35
    v_mul_u32_u24 v35, 7168, v35
    v_add3_u32 v35, v35, v29, s56
    v_subrev_u32 v35, 3072, v35
    s_mov_b32 s71, 0
    s_mov_b32 s73, 0x76543210
    s_add_u32 s58, s71, s62
    s_and_b32 s59, s71, 28
    s_lshr_b32 s59, s73, s59
    s_and_b32 s59, s59, 7
    s_and_b32 s58, s58, 3
    s_lshl2_add_u32 s58, s59, s58
    s_mul_i32 s67, s58, 7168
    s_mul_i32 s68, s58, 131072
    s_lshl_b32 s69, s70, 12
    s_mov_b32 s36, s4
    s_mov_b32 s37, s5
    s_mov_b32 s38, 0xe00000
    s_mov_b32 s39, 0x00020000
    s_cmp_ge_u32 s30, 28
    s_cselect_b32 s38, 0, s38
    v_lshlrev_b32 v26, 7, v1
    s_lshl_b32 s58, s2, 3
    s_add_u32 s58, s58, s28
    s_cmp_lg_u32 s58, 4
    s_cbranch_scc1 L_pb_176
    s_waitcnt vmcnt(2)
    v_readfirstlane_b32 s58, v25
    s_add_u32 s58, s58, 1
    s_cbranch_scc0 L_pz_177
    v_mov_b32 v25, 1
    s_mov_b64 exec, 1
    buffer_atomic_add v25, v24, s[24:27], 0 offen sc0 sc1
    s_waitcnt vmcnt(0)
    s_mov_b32 s58, 1
L_pz_177:
    s_mov_b64 exec, -1
    v_mov_b32 v25, s58
    s_mov_b64 exec, 3
    buffer_store_dword v25, v26, s[48:51], 0 offen sc1
    s_mov_b64 exec, -1
L_pb_176:
    s_waitcnt vmcnt(0)
    s_branch L_ln_171
L_consts_170:
    v_mul_f32 v3, v110, v111
    v_mul_f32 v3, 0x3b800000, v3
    v_fmamk_f32 v80, v110, 0x00000000, v3
    v_fmamk_f32 v81, v110, 0x3a800000, v3
    v_fmamk_f32 v82, v110, 0x3b000000, v3
    v_fmamk_f32 v83, v110, 0x3b400000, v3
    v_fmamk_f32 v84, v110, 0x3c000000, v3
    v_fmamk_f32 v85, v110, 0x3c100000, v3
    v_fmamk_f32 v86, v110, 0x3c200000, v3
    v_fmamk_f32 v87, v110, 0x3c300000, v3
    v_fmamk_f32 v88, v110, 0x3c800000, v3
    v_fmamk_f32 v89, v110, 0x3c880000, v3
    v_fmamk_f32 v90, v110, 0x3c900000, v3
    v_fmamk_f32 v91, v110, 0x3c980000, v3
    v_fmamk_f32 v92, v110, 0x3cc00000, v3
    v_fmamk_f32 v93, v110, 0x3cc80000, v3
    v_fmamk_f32 v94, v110, 0x3cd00000, v3
    v_fmamk_f32 v95, v110, 0x3cd80000, v3
    v_cos_f32 v64, v80
    v_sin_f32 v80, v80
    v_cos_f32 v65, v81
    v_sin_f32 v81, v81
    v_cos_f32 v66, v82
    v_sin_f32 v82, v82
    v_cos_f32 v67, v83
    v_sin_f32 v83, v83
    v_cos_f32 v68, v84
    v_sin_f32 v84, v84
    v_cos_f32 v69, v85
    v_sin_f32 v85, v85
    v_cos_f32 v70, v86
    v_sin_f32 v86, v86
    v_cos_f32 v71, v87
    v_sin_f32 v87, v87
    v_cos_f32 v72, v88
    v_sin_f32 v88, v88
    v_cos_f32 v73, v89
    v_sin_f32 v89, v89
    v_cos_f32 v74, v90
    v_sin_f32 v90, v90
    v_cos_f32 v75, v91
    v_sin_f32 v91, v91
    v_cos_f32 v76, v92
    v_sin_f32 v92, v92
    v_cos_f32 v77, v93
    v_sin_f32 v93, v93
    v_cos_f32 v78, v94
    v_sin_f32 v94, v94
    v_cos_f32 v79, v95
    v_sin_f32 v95, v95
    s_waitcnt vmcnt(0)
L_ln_171:
    s_mov_b32 s80, s18
    s_mov_b32 s81, s19
    s_mov_b32 s82, 0x400000
    s_mov_b32 s83, 0x00020000
    s_add_u32 s84, s18, 0x800000
    s_addc_u32 s85, s19, 0
    s_mov_b32 s86, 0x40d080
    s_mov_b32 s87, 0x00020000
    s_mul_i32 s88, s28, 2112
    s_add_u32 s88, s88, 65536
    v_add_u32 v4, s88, v2
    v_lshlrev_b32 v8, 16, v96
    v_and_b32 v9, 0xffff0000, v96
    v_lshlrev_b32 v10, 16, v97
    v_and_b32 v11, 0xffff0000, v97
    v_lshlrev_b32 v12, 16, v98
    v_and_b32 v13, 0xffff0000, v98
    v_lshlrev_b32 v14, 16, v99
    v_and_b32 v15, 0xffff0000, v99
    v_lshlrev_b32 v16, 16, v100
    v_and_b32 v17, 0xffff0000, v100
    v_lshlrev_b32 v18, 16, v101
    v_and_b32 v19, 0xffff0000, v101
    v_lshlrev_b32 v20, 16, v102
    v_and_b32 v21, 0xffff0000, v102
    v_lshlrev_b32 v22, 16, v103
    v_and_b32 v23, 0xffff0000, v103
    v_readfirstlane_b32 s90, v8
    s_nop 1
    v_pk_add_f32 v[8:9], v[8:9], s[90:91] op_sel_hi:[1,0] neg_lo:[0,1] neg_hi:[0,1]
    v_pk_add_f32 v[10:11], v[10:11], s[90:91] op_sel_hi:[1,0] neg_lo:[0,1] neg_hi:[0,1]
    v_pk_add_f32 v[12:13], v[12:13], s[90:91] op_sel_hi:[1,0] neg_lo:[0,1] neg_hi:[0,1]
    v_pk_add_f32 v[14:15], v[14:15], s[90:91] op_sel_hi:[1,0] neg_lo:[0,1] neg_hi:[0,1]
    v_pk_add_f32 v[16:17], v[16:17], s[90:91] op_sel_hi:[1,0] neg_lo:[0,1] neg_hi:[0,1]
    v_pk_add_f32 v[18:19], v[18:19], s[90:91] op_sel_hi:[1,0] neg_lo:[0,1] neg_hi:[0,1]
    v_pk_add_f32 v[20:21], v[20:21], s[90:91] op_sel_hi:[1,0] neg_lo:[0,1] neg_hi:[0,1]
    v_pk_add_f32 v[22:23], v[22:23], s[90:91] op_sel_hi:[1,0] neg_lo:[0,1] neg_hi:[0,1]
    v_pk_add_f32 v[104:105], v[8:9], v[10:11]
    v_pk_mul_f32 v[106:107], v[8:9], v[8:9]
    v_pk_fma_f32 v[106:107], v[10:11], v[10:11], v[106:107]
    v_pk_add_f32 v[104:105], v[104:105], v[12:13]
    v_pk_fma_f32 v[106:107], v[12:13], v[12:13], v[106:107]
    v_pk_add_f32 v[104:105], v[104:105], v[14:15]
    v_pk_fma_f32 v[106:107], v[14:15], v[14:15], v[106:107]
    v_pk_add_f32 v[104:105], v[104:105], v[16:17]
    v_pk_fma_f32 v[106:107], v[16:17], v[16:17], v[106:107]
    v_pk_add_f32 v[104:105], v[104:105], v[18:19]
    v_pk_fma_f32 v[106:107], v[18:19], v[18:19], v[106:107]
    v_pk_add_f32 v[104:105], v[104:105], v[20:21]
    v_pk_fma_f32 v[106:107], v[20:21], v[20:21], v[106:107]
    v_pk_add_f32 v[104:105], v[104:105], v[22:23]
    v_pk_fma_f32 v[106:107], v[22:23], v[22:23], v[106:107]
    v_add_f32 v104, v104, v105
    v_add_f32 v106, v106, v107
    s_nop 0
    v_add_f32_dpp v104, v104, v104 row_ror:8
    v_add_f32_dpp v106, v106, v106 row_ror:8
    s_nop 0
    v_add_f32_dpp v104, v104, v104 row_ror:4
    v_add_f32_dpp v106, v106, v106 row_ror:4
    s_nop 0
    v_add_f32_dpp v104, v104, v104 row_ror:2
    v_add_f32_dpp v106, v106, v106 row_ror:2
    s_nop 0
    v_add_f32_dpp v104, v104, v104 row_ror:1
    v_add_f32_dpp v106, v106, v106 row_ror:1
    s_nop 0
    v_add_f32_dpp v104, v104, v104 row_bcast:15 row_mask:0xa
    v_add_f32_dpp v106, v106, v106 row_bcast:15 row_mask:0xa
    s_nop 0
    v_add_f32_dpp v104, v104, v104 row_bcast:31 row_mask:0xc
    v_add_f32_dpp v106, v106, v106 row_bcast:31 row_mask:0xc
    v_mul_f32 v104, 0x3a800000, v104
    v_mul_f32 v106, 0x3a800000, v106
    v_fma_f32 v106, -v104, v104, v106
    v_max_f32 v106, 0, v106
    v_add_f32 v108, 0x3727c5ac, v106
    v_rsq_f32 v108, v108
    v_mov_b32 v109, 0x3727c5ac
    v_mul_f32 v106, v106, v108
    v_mul_f32 v104, v104, v108
    v_fma_f32 v106, v106, v108, v109
    v_readlane_b32 s94, v108, 63
    v_readlane_b32 s92, v104, 63
    v_rsq_f32 v106, v106
    s_nop 0
    v_mov_b32 v104, s92
    v_pk_fma_f32 v[8:9], v[8:9], s[94:95], v[104:105] op_sel_hi:[1,0,0] neg_lo:[0,0,1] neg_hi:[0,0,1]
    v_readlane_b32 s96, v106, 63
    v_pk_fma_f32 v[10:11], v[10:11], s[94:95], v[104:105] op_sel_hi:[1,0,0] neg_lo:[0,0,1] neg_hi:[0,0,1]
    v_pk_fma_f32 v[12:13], v[12:13], s[94:95], v[104:105] op_sel_hi:[1,0,0] neg_lo:[0,0,1] neg_hi:[0,0,1]
    v_pk_fma_f32 v[14:15], v[14:15], s[94:95], v[104:105] op_sel_hi:[1,0,0] neg_lo:[0,0,1] neg_hi:[0,0,1]
    v_pk_fma_f32 v[16:17], v[16:17], s[94:95], v[104:105] op_sel_hi:[1,0,0] neg_lo:[0,0,1] neg_hi:[0,0,1]
    v_pk_fma_f32 v[18:19], v[18:19], s[94:95], v[104:105] op_sel_hi:[1,0,0] neg_lo:[0,0,1] neg_hi:[0,0,1]
    v_pk_fma_f32 v[20:21], v[20:21], s[94:95], v[104:105] op_sel_hi:[1,0,0] neg_lo:[0,0,1] neg_hi:[0,0,1]
    v_pk_fma_f32 v[22:23], v[22:23], s[94:95], v[104:105] op_sel_hi:[1,0,0] neg_lo:[0,0,1] neg_hi:[0,0,1]
    v_cvt_pk_bf16_f32 v96, v8, v9
    v_cvt_pk_bf16_f32 v97, v10, v11
    v_cvt_pk_bf16_f32 v98, v12, v13
    v_cvt_pk_bf16_f32 v99, v14, v15
    v_cvt_pk_bf16_f32 v100, v16, v17
    v_cvt_pk_bf16_f32 v101, v18, v19
    v_cvt_pk_bf16_f32 v102, v20, v21
    v_cvt_pk_bf16_f32 v103, v22, v23
    ds_write_b128 v4, v[96:99] offset:0
    ds_write_b128 v4, v[100:103] offset:1024
    v_pk_mul_f32 v[8:9], v[8:9], s[96:97] op_sel_hi:[1,0]
    v_pk_mul_f32 v[10:11], v[10:11], s[96:97] op_sel_hi:[1,0]
    v_pk_mul_f32 v[12:13], v[12:13], s[96:97] op_sel_hi:[1,0]
    v_pk_mul_f32 v[14:15], v[14:15], s[96:97] op_sel_hi:[1,0]
    v_pk_mul_f32 v[16:17], v[16:17], s[96:97] op_sel_hi:[1,0]
    v_pk_mul_f32 v[18:19], v[18:19], s[96:97] op_sel_hi:[1,0]
    v_pk_mul_f32 v[20:21], v[20:21], s[96:97] op_sel_hi:[1,0]
    v_pk_mul_f32 v[22:23], v[22:23], s[96:97] op_sel_hi:[1,0]
    v_cvt_pk_bf16_f32 v112, v8, v9
    v_cvt_pk_bf16_f32 v113, v10, v11
    v_cvt_pk_bf16_f32 v114, v12, v13
    v_cvt_pk_bf16_f32 v115, v14, v15
    v_cvt_pk_bf16_f32 v116, v16, v17
    v_cvt_pk_bf16_f32 v117, v18, v19
    v_cvt_pk_bf16_f32 v118, v20, v21
    v_cvt_pk_bf16_f32 v119, v22, v23
    ds_write_b128 v4, v[112:115] offset:16896
    ds_write_b128 v4, v[116:119] offset:17920
    v_bfe_u32 v3, v1, 2, 2
    v_and_b32 v4, 3, v1
    v_lshlrev_b32 v4, 3, v4
    s_cmp_ge_u32 s28, 4
    s_cbranch_scc1 L_hb_172
    s_and_b32 s58, s29, 1
    s_lshl_b32 s58, s58, 2
    s_and_b32 s57, s30, 3
    s_add_u32 s57, s57, s58
    s_lshl_b32 s57, s57, 11
    s_lshr_b32 s58, s29, 1
    s_mul_i32 s58, s58, 7
    s_lshr_b32 s56, s30, 2
    s_add_u32 s56, s56, s58
    s_lshl_b32 s56, s56, 8
    s_and_b32 s60, s28, 1
    s_mov_b32 s44, s6
    s_mov_b32 s45, s7
    s_mov_b32 s46, 0x1c00
    s_mov_b32 s47, 0x00020000
    v_lshrrev_b32 v24, 5, v1
    v_lshlrev_b32 v24, 3, v24
    s_lshl_b32 s58, s60, 7
    s_add_u32 s58, s58, s56
    v_add_u32 v24, s58, v24
    buffer_load_dwordx2 v[160:161], v24, s[44:47], 0 offen offset:0
    buffer_load_dwordx2 v[162:163], v24, s[44:47], 0 offen offset:16
    buffer_load_dwordx2 v[164:165], v24, s[44:47], 0 offen offset:32
    buffer_load_dwordx2 v[166:167], v24, s[44:47], 0 offen offset:48
    buffer_load_dwordx2 v[168:169], v24, s[44:47], 0 offen offset:64
    buffer_load_dwordx2 v[170:171], v24, s[44:47], 0 offen offset:80
    buffer_load_dwordx2 v[172:173], v24, s[44:47], 0 offen offset:96
    buffer_load_dwordx2 v[174:175], v24, s[44:47], 0 offen offset:112
    s_and_b32 s58, s29, 1
    s_lshl_b32 s58, s58, 2
    s_and_b32 s57, s30, 3
    s_add_u32 s57, s57, s58
    s_lshl_b32 s57, s57, 11
    s_bfe_u32 s63, s2, 0x10002
    s_bfe_u32 s58, s2, 0x10001
    s_lshl_b32 s58, s58, 3
    s_lshr_b32 s56, s30, 2
    s_add_u32 s56, s56, s58
    s_lshl_b32 s56, s56, 8
    s_mov_b32 s52, s10
    s_mov_b32 s53, s11
    s_mov_b32 s54, 0x1000
    s_mov_b32 s55, 0x00020000
    v_and_b32 v176, 31, v1
    s_lshl_b32 s58, s60, 7
    s_add_u32 s58, s58, s56
    v_lshl_add_u32 v176, v176, 1, s58
    s_lshl_b32 s70, s63, 6
    buffer_load_ushort v176, v176, s[52:55], s70 offen
    v_lshl_add_u32 v4, v3, 6, v4
    v_lshrrev_b32 v3, 5, v1
    v_lshl_add_u32 v4, v3, 8, v4
    v_bfe_u32 v3, v1, 4, 1
    v_lshl_add_u32 v4, v3, 5, v4
    v_add_u32 v4, s88, v4
    s_waitcnt lgkmcnt(0)
    s_barrier
    ds_read_b64_tr_b16 v[8:9], v4 offset:0
    ds_read_b64_tr_b16 v[10:11], v4 offset:512
    ds_read_b64_tr_b16 v[16:17], v4 offset:8448
    ds_read_b64_tr_b16 v[18:19], v4 offset:8960
    ds_read_b64_tr_b16 v[12:13], v4 offset:1024
    ds_read_b64_tr_b16 v[14:15], v4 offset:1536
    ds_read_b64_tr_b16 v[20:21], v4 offset:9472
    ds_read_b64_tr_b16 v[22:23], v4 offset:9984
    v_and_b32 v3, 31, v1
    v_lshrrev_b32 v4, 5, v1
    v_lshl_add_u32 v3, v4, 7, v3
    s_lshl_b32 s88, s28, 2
    s_add_u32 s88, s88, 65536
    v_lshl_add_u32 v3, v3, 4, s88
    s_waitcnt lgkmcnt(4)
    v_mfma_f32_32x32x16_bf16 v[96:111], v[8:11], v[40:43], 0
    v_mfma_f32_32x32x16_bf16 v[112:127], v[16:19], v[40:43], 0
    v_mfma_f32_32x32x16_bf16 v[96:111], v[16:19], v[48:51], v[96:111]
    v_mfma_f32_32x32x16_bf16 v[112:127], v[8:11], v[56:59], v[112:127]
    s_waitcnt lgkmcnt(0)
    v_mfma_f32_32x32x16_bf16 v[96:111], v[12:15], v[44:47], v[96:111]
    v_mfma_f32_32x32x16_bf16 v[112:127], v[20:23], v[44:47], v[112:127]
    v_mfma_f32_32x32x16_bf16 v[96:111], v[20:23], v[52:55], v[96:111]
    v_mfma_f32_32x32x16_bf16 v[112:127], v[12:15], v[60:63], v[112:127]
    s_nop 10
    v_pk_mul_f32 v[24:25], v[96:97], v[80:81]
    v_pk_mul_f32 v[26:27], v[98:99], v[82:83]
    v_pk_mul_f32 v[28:29], v[100:101], v[84:85]
    v_pk_mul_f32 v[30:31], v[102:103], v[86:87]
    v_pk_mul_f32 v[32:33], v[104:105], v[88:89]
    v_pk_mul_f32 v[34:35], v[106:107], v[90:91]
    v_pk_mul_f32 v[36:37], v[108:109], v[92:93]
    v_pk_mul_f32 v[38:39], v[110:111], v[94:95]
    v_pk_mul_f32 v[96:97], v[96:97], v[64:65]
    v_pk_mul_f32 v[98:99], v[98:99], v[66:67]
    v_pk_mul_f32 v[100:101], v[100:101], v[68:69]
    v_pk_mul_f32 v[102:103], v[102:103], v[70:71]
    v_pk_mul_f32 v[104:105], v[104:105], v[72:73]
    v_pk_mul_f32 v[106:107], v[106:107], v[74:75]
    v_pk_mul_f32 v[108:109], v[108:109], v[76:77]
    v_pk_mul_f32 v[110:111], v[110:111], v[78:79]
    v_pk_fma_f32 v[96:97], v[112:113], v[80:81], v[96:97]
    v_pk_fma_f32 v[98:99], v[114:115], v[82:83], v[98:99]
    v_pk_fma_f32 v[100:101], v[116:117], v[84:85], v[100:101]
    v_pk_fma_f32 v[102:103], v[118:119], v[86:87], v[102:103]
    v_pk_fma_f32 v[104:105], v[120:121], v[88:89], v[104:105]
    v_pk_fma_f32 v[106:107], v[122:123], v[90:91], v[106:107]
    v_pk_fma_f32 v[108:109], v[124:125], v[92:93], v[108:109]
    v_pk_fma_f32 v[110:111], v[126:127], v[94:95], v[110:111]
    v_pk_fma_f32 v[112:113], v[112:113], v[64:65], v[24:25] neg_lo:[0,0,1] neg_hi:[0,0,1]
    v_pk_fma_f32 v[114:115], v[114:115], v[66:67], v[26:27] neg_lo:[0,0,1] neg_hi:[0,0,1]
    v_pk_fma_f32 v[116:117], v[116:117], v[68:69], v[28:29] neg_lo:[0,0,1] neg_hi:[0,0,1]
    v_pk_fma_f32 v[118:119], v[118:119], v[70:71], v[30:31] neg_lo:[0,0,1] neg_hi:[0,0,1]
    v_pk_fma_f32 v[120:121], v[120:121], v[72:73], v[32:33] neg_lo:[0,0,1] neg_hi:[0,0,1]
    v_pk_fma_f32 v[122:123], v[122:123], v[74:75], v[34:35] neg_lo:[0,0,1] neg_hi:[0,0,1]
    v_pk_fma_f32 v[124:125], v[124:125], v[76:77], v[36:37] neg_lo:[0,0,1] neg_hi:[0,0,1]
    v_pk_fma_f32 v[126:127], v[126:127], v[78:79], v[38:39] neg_lo:[0,0,1] neg_hi:[0,0,1]
    v_cvt_pk_bf16_f32 v8, v96, v97
    v_cvt_pk_bf16_f32 v9, v98, v99
    v_cvt_pk_bf16_f32 v10, v100, v101
    v_cvt_pk_bf16_f32 v11, v102, v103
    v_cvt_pk_bf16_f32 v12, v104, v105
    v_cvt_pk_bf16_f32 v13, v106, v107
    v_cvt_pk_bf16_f32 v14, v108, v109
    v_cvt_pk_bf16_f32 v15, v110, v111
    v_cvt_pk_bf16_f32 v16, v112, v113
    v_cvt_pk_bf16_f32 v17, v114, v115
    v_cvt_pk_bf16_f32 v18, v116, v117
    v_cvt_pk_bf16_f32 v19, v118, v119
    v_cvt_pk_bf16_f32 v20, v120, v121
    v_cvt_pk_bf16_f32 v21, v122, v123
    v_cvt_pk_bf16_f32 v22, v124, v125
    v_cvt_pk_bf16_f32 v23, v126, v127
    v_mfma_f32_32x32x16_bf16 v[96:111], v[40:43], v[8:11], 0
    v_mfma_f32_32x32x16_bf16 v[112:127], v[40:43], v[16:19], 0
    v_mfma_f32_32x32x16_bf16 v[96:111], v[48:51], v[16:19], v[96:111]
    v_mfma_f32_32x32x16_bf16 v[112:127], v[56:59], v[8:11], v[112:127]
    v_mfma_f32_32x32x16_bf16 v[96:111], v[44:47], v[12:15], v[96:111]
    v_mfma_f32_32x32x16_bf16 v[112:127], v[44:47], v[20:23], v[112:127]
    v_mfma_f32_32x32x16_bf16 v[96:111], v[52:55], v[20:23], v[96:111]
    v_mfma_f32_32x32x16_bf16 v[112:127], v[60:63], v[12:15], v[112:127]
    s_nop 11
    v_cvt_pk_bf16_f32 v8, v96, v112
    ds_write_b32 v3, v8 offset:33792
    v_cvt_pk_bf16_f32 v9, v97, v113
    ds_write_b32 v3, v9 offset:34304
    v_cvt_pk_bf16_f32 v10, v98, v114
    ds_write_b32 v3, v10 offset:34816
    v_cvt_pk_bf16_f32 v11, v99, v115
    ds_write_b32 v3, v11 offset:35328
    v_cvt_pk_bf16_f32 v12, v100, v116
    ds_write_b32 v3, v12 offset:37888
    v_cvt_pk_bf16_f32 v13, v101, v117
    ds_write_b32 v3, v13 offset:38400
    v_cvt_pk_bf16_f32 v14, v102, v118
    ds_write_b32 v3, v14 offset:38912
    v_cvt_pk_bf16_f32 v15, v103, v119
    ds_write_b32 v3, v15 offset:39424
    v_cvt_pk_bf16_f32 v16, v104, v120
    ds_write_b32 v3, v16 offset:42096
    v_cvt_pk_bf16_f32 v17, v105, v121
    ds_write_b32 v3, v17 offset:42608
    v_cvt_pk_bf16_f32 v18, v106, v122
    ds_write_b32 v3, v18 offset:43120
    v_cvt_pk_bf16_f32 v19, v107, v123
    ds_write_b32 v3, v19 offset:43632
    v_cvt_pk_bf16_f32 v20, v108, v124
    ds_write_b32 v3, v20 offset:46192
    v_cvt_pk_bf16_f32 v21, v109, v125
    ds_write_b32 v3, v21 offset:46704
    v_cvt_pk_bf16_f32 v22, v110, v126
    ds_write_b32 v3, v22 offset:47216
    v_cvt_pk_bf16_f32 v23, v111, v127
    ds_write_b32 v3, v23 offset:47728
    s_mov_b64 exec, 1
    ds_write_b32 v3, v8 offset:50288
    ds_write_b32 v3, v16 offset:41984
    s_mov_b64 exec, -1
    s_branch L_z_173
L_hb_172:
    v_mul_u32_u24 v3, 2112, v3
    v_add_u32 v4, v3, v4
    v_lshrrev_b32 v3, 4, v1
    v_lshl_add_u32 v4, v3, 5, v4
    s_sub_u32 s88, s28, 4
    s_lshl_b32 s89, s88, 9
    s_add_u32 s89, s89, 65536
    v_add_u32 v4, s89, v4
    s_lshl_b32 s88, s88, 12
    s_lshl_b32 s89, s2, 14
    s_add_u32 s89, s89, s88
    s_waitcnt lgkmcnt(0)
    s_barrier
    s_setprio 2
    s_and_b32 s58, s2, 1
    s_lshl_b32 s58, s58, 7
    v_mov_b32 v24, s58
    s_cmp_lg_u32 s28, 4
    s_cbranch_scc1 L_ah_178
    buffer_load_dword v25, v24, s[48:51], 0 offen sc1
L_ah_178:
    ds_read_b64_tr_b16 v[8:9], v4 offset:16896
    ds_read_b64_tr_b16 v[10:11], v4 offset:25344
    ds_read_b64_tr_b16 v[12:13], v4 offset:17024
    ds_read_b64_tr_b16 v[14:15], v4 offset:25472
    ds_read_b64_tr_b16 v[16:17], v4 offset:17152
    ds_read_b64_tr_b16 v[18:19], v4 offset:25600
    ds_read_b64_tr_b16 v[20:21], v4 offset:17280
    ds_read_b64_tr_b16 v[22:23], v4 offset:25728
    s_waitcnt lgkmcnt(6)
    buffer_store_dwordx4 v[8:11], v2, s[80:83], s89 offen offset:0 sc1
    s_waitcnt lgkmcnt(4)
    buffer_store_dwordx4 v[12:15], v2, s[80:83], s89 offen offset:1024 sc1
    s_waitcnt lgkmcnt(2)
    buffer_store_dwordx4 v[16:19], v2, s[80:83], s89 offen offset:2048 sc1
    s_waitcnt lgkmcnt(0)
    buffer_store_dwordx4 v[20:23], v2, s[80:83], s89 offen offset:3072 sc1
    s_cmp_lg_u32 s28, 4
    s_cbranch_scc1 L_hd_181
    s_waitcnt vmcnt(4)
    s_mov_b32 s66, 131072
L_hdr_182:
    v_readfirstlane_b32 s31, v25
    s_cmp_lg_u32 s31, 0
    s_cbranch_scc1 L_hdg_183
    s_sub_u32 s66, s66, 1
    s_cbranch_scc1 L_hdg_183
    s_sleep 2
    buffer_load_dword v25, v24, s[48:51], 0 offen sc1
    s_waitcnt vmcnt(0)
    s_branch L_hdr_182
L_hdg_183:
    v_mov_b32 v26, 141312
    ds_write_b32 v26, v25 offset:28
    s_waitcnt lgkmcnt(0)
L_hd_181:
    s_waitcnt vmcnt(0)
    v_mov_b32 v26, 141312
L_lw_184:
    ds_read_b32 v27, v26 offset:28
    s_waitcnt lgkmcnt(0)
    v_readfirstlane_b32 s58, v27
    s_cmp_lt_u32 s58, 1
    s_cbranch_scc1 L_lw_184
    s_lshr_b32 s58, s2, 2
    s_lshl_b32 s58, s58, 5
    s_and_b32 s101, s2, 3
    s_add_u32 s58, s58, s101
    s_lshl_b32 s58, s58, 2
    s_add_u32 s58, s58, 180224
    v_mov_b32 v28, 141312
    v_mov_b32 v29, 1
    v_mov_b32 v31, s58
    s_mov_b64 exec, 1
    ds_add_rtn_u32 v29, v28, v29 offset:20
    ds_read_b32 v30, v28 offset:28
    s_waitcnt lgkmcnt(0)
    v_readfirstlane_b32 s58, v29
    v_readfirstlane_b32 s31, v30
    s_cmp_lg_u32 s58, 3
    s_cbranch_scc1 L_na_185
    buffer_store_dword v30, v31, s[24:27], 0 offen sc1
L_na_185:
    s_mov_b64 exec, -1
    v_mov_b32 v24, 141312
    v_mov_b32 v25, 1
L_lw_186:
    ds_read_b32 v26, v24 offset:56
    s_waitcnt lgkmcnt(0)
    v_readfirstlane_b32 s58, v26
    s_cmp_lt_u32 s58, 4
    s_cbranch_scc1 L_lw_186
    s_lshr_b32 s98, s2, 5
    s_lshl_b32 s98, s98, 3
    s_and_b32 s88, s2, 7
    s_or_b32 s98, s98, s88
    s_bfe_u32 s99, s2, 0x20003
    s_and_b32 s89, s98, 3
    s_lshl_b32 s89, s89, 2
    s_add_u32 s89, s89, s70
    s_lshl_b32 s89, s89, 1
    s_bfe_u32 s88, s98, 0x30002
    s_lshl_b32 s88, s88, 8
    s_add_u32 s89, s89, s88
    s_lshr_b32 s88, s98, 5
    s_lshl_b32 s88, s88, 5
    s_add_u32 s89, s89, s88
    s_mul_i32 s89, s89, 1026
    s_lshl_b32 s88, s99, 8
    s_add_u32 s89, s89, s88
    v_lshrrev_b32 v3, 4, v1
    v_and_b32 v4, 15, v1
    v_lshlrev_b32 v4, 4, v4
    v_mul_u32_u24 v6, 640, v3
    v_add_u32 v6, v6, v4
    v_mul_u32_u24 v3, 65664, v3
    v_add_u32 v3, v3, v4
    s_mov_b32 s76, s14
    s_mov_b32 s77, s15
    s_mov_b32 s78, 0x201000
    s_mov_b32 s79, 0x00020000
    s_mov_b32 s84, s16
    s_mov_b32 s85, s17
    s_mov_b32 s86, 0x201000
    s_mov_b32 s87, 0x00020000
    buffer_load_dwordx4 v[64:67], v3, s[76:79], s89 offen offset:0
    buffer_load_dwordx4 v[68:71], v3, s[84:87], s89 offen offset:0
    buffer_load_dwordx4 v[72:75], v3, s[76:79], s89 offen offset:1026
    buffer_load_dwordx4 v[76:79], v3, s[84:87], s89 offen offset:1026
    v_bfe_u32 v3, v1, 2, 1
    s_lshl_b32 s88, s98, 2
    s_add_u32 s88, s88, s99
    s_lshl_b32 s88, s88, 1
    v_add_u32 v40, s88, v3
    v_and_b32 v41, 3, v1
    v_and_b32 v3, 31, v40
    v_lshl_add_u32 v3, v41, 6, v3
    v_bfe_u32 v4, v40, 5, 3
    v_lshl_add_u32 v3, v4, 8, v3
    v_lshrrev_b32 v4, 8, v40
    v_lshl_add_u32 v3, v4, 5, v3
    v_mul_u32_u24 v3, 1026, v3
    v_lshlrev_b32 v40, 4, v40
    v_lshl_add_u32 v40, v41, 2, v40
    buffer_load_ushort v41, v3, s[76:79], 0 offen offset:1024
    buffer_load_ushort v42, v3, s[84:87], 0 offen offset:1024
    s_add_u32 s40, s18, 0x1000000
    s_addc_u32 s41, s19, 0
    s_mov_b32 s42, 0x412080
    s_mov_b32 s43, 0x00020000
    s_mov_b32 s88, s70
    s_mul_i32 s89, s88, 5120
    s_add_u32 s89, s89, 65536
    v_add_u32 v6, s89, v6
    v_bfe_u32 v3, v1, 2, 2
    v_mul_u32_u24 v3, 320, v3
    v_and_b32 v4, 3, v1
    v_lshl_add_u32 v3, v4, 3, v3
    v_lshrrev_b32 v4, 4, v1
    v_lshl_add_u32 v3, v4, 5, v3
    v_add_u32 v3, s89, v3
    v_lshrrev_b32 v4, 3, v1
    v_mul_u32_u24 v5, 65664, v4
    v_and_b32 v4, 7, v1
    v_lshl_add_u32 v5, v4, 4, v5
    s_lshl_b32 s89, s98, 2
    s_add_u32 s89, s89, s88
    s_lshl_b32 s89, s89, 8
    s_mul_i32 s88, s99, 1050624
    s_add_u32 s89, s89, s88
    s_add_u32 s88, s89, 525312
    s_waitcnt vmcnt(2)
    ds_write_b128 v6, v[64:67] offset:51200
    ds_write_b128 v6, v[68:71] offset:51520
    ds_write_b128 v6, v[72:75] offset:53760
    ds_write_b128 v6, v[76:79] offset:54080
    s_waitcnt lgkmcnt(0)
    ds_read_b64_tr_b16 v[80:81], v3 offset:51200
    ds_read_b64_tr_b16 v[82:83], v3 offset:52480
    ds_read_b64_tr_b16 v[84:85], v3 offset:51328
    ds_read_b64_tr_b16 v[86:87], v3 offset:52608
    ds_read_b64_tr_b16 v[88:89], v3 offset:53760
    ds_read_b64_tr_b16 v[90:91], v3 offset:55040
    ds_read_b64_tr_b16 v[92:93], v3 offset:53888
    ds_read_b64_tr_b16 v[94:95], v3 offset:55168
    s_waitcnt vmcnt(0)
    v_lshl_or_b32 v41, v42, 16, v41
    s_mov_b32 s99, 4202496
    buffer_store_dword v41, v40, s[40:43], s99 offen sc1
    s_waitcnt lgkmcnt(6)
    buffer_store_dwordx4 v[80:83], v5, s[40:43], s89 offen offset:0 sc1
    s_waitcnt lgkmcnt(4)
    buffer_store_dwordx4 v[84:87], v5, s[40:43], s88 offen offset:0 sc1
    s_waitcnt lgkmcnt(2)
    buffer_store_dwordx4 v[88:91], v5, s[40:43], s89 offen offset:128 sc1
    s_waitcnt lgkmcnt(0)
    buffer_store_dwordx4 v[92:95], v5, s[40:43], s88 offen offset:128 sc1
L_gw_187:
    s_cmp_ge_u32 s30, 28
    s_cbranch_scc1 L_nwi_188
    v_mov_b32 v28, 141312
L_lw_189:
    ds_read_b32 v29, v28 offset:44
    s_waitcnt lgkmcnt(0)
    v_readfirstlane_b32 s58, v29
    s_cmp_lt_u32 s58, 1
    s_cbranch_scc1 L_lw_189
    s_mov_b32 m0, s69
    s_nop 0
    buffer_load_dwordx4 v32, s[36:39], s67 offen offset:0  lds
    buffer_load_dwordx4 v33, s[36:39], s67 offen offset:1024  lds
    buffer_load_dwordx4 v34, s[36:39], s67 offen offset:2048  lds
    buffer_load_dwordx4 v35, s[36:39], s67 offen offset:3072  lds
    s_add_u32 s71, s71, 1
    s_add_u32 s58, s71, s62
    s_and_b32 s59, s71, 28
    s_lshr_b32 s59, s73, s59
    s_and_b32 s59, s59, 7
    s_and_b32 s58, s58, 3
    s_lshl2_add_u32 s58, s59, s58
    s_mul_i32 s67, s58, 7168
    s_mul_i32 s68, s58, 131072
    s_add_u32 s69, s69, 32768
    s_cmp_ge_u32 s69, 98304
    s_cselect_b32 s58, 98304, 0
    s_sub_u32 s69, s69, s58
    s_mov_b32 m0, s69
    s_nop 0
    buffer_load_dwordx4 v32, s[36:39], s67 offen offset:0  lds
    buffer_load_dwordx4 v33, s[36:39], s67 offen offset:1024  lds
    buffer_load_dwordx4 v34, s[36:39], s67 offen offset:2048  lds
    buffer_load_dwordx4 v35, s[36:39], s67 offen offset:3072  lds
L_nwi_188:
    s_setprio 0
    s_branch L_k1r_8
L_z_173:
    v_lshrrev_b32 v4, 3, v1
    s_lshl_b32 s88, s28, 5
    v_add_u32 v4, s88, v4
    v_mul_u32_u24 v3, 32896, v4
    v_and_b32 v4, 7, v1
    v_lshl_add_u32 v3, v4, 4, v3
    s_lshl_b32 s88, s28, 12
    s_add_u32 s88, s88, 65536
    v_add_u32 v4, s88, v2
    s_and_b32 s88, s2, 7
    s_lshl_b32 s88, s88, 5
    s_lshr_b32 s89, s2, 3
    s_add_u32 s89, s89, s88
    s_lshl_b32 s89, s89, 7
    s_add_u32 s91, s89, 263168
    s_add_u32 s92, s89, 526336
    s_add_u32 s93, s89, 789504
    s_add_u32 s94, s89, 1052672
    s_waitcnt lgkmcnt(0)
    v_mov_b32 v24, 141312
    v_mov_b32 v25, 1
    s_mov_b64 exec, 1
    ds_add_u32 v24, v25 offset:52
    s_mov_b64 exec, -1
L_lw_191:
    ds_read_b32 v26, v24 offset:52
    s_waitcnt lgkmcnt(0)
    v_readfirstlane_b32 s58, v26
    s_cmp_lt_u32 s58, 4
    s_cbranch_scc1 L_lw_191
    ds_read_b128 v[24:27], v4 offset:33792
    ds_read_b128 v[28:31], v4 offset:34816
    ds_read_b128 v[32:35], v4 offset:35840
    ds_read_b128 v[36:39], v4 offset:36864
    ds_read_b128 v[8:11], v4 offset:37888
    s_waitcnt lgkmcnt(4)
    buffer_store_dwordx4 v[24:27], v3, s[84:87], s89 offen sc1
    s_waitcnt lgkmcnt(3)
    buffer_store_dwordx4 v[28:31], v3, s[84:87], s91 offen sc1
    s_waitcnt lgkmcnt(2)
    buffer_store_dwordx4 v[32:35], v3, s[84:87], s92 offen sc1
    s_waitcnt lgkmcnt(1)
    buffer_store_dwordx4 v[36:39], v3, s[84:87], s93 offen sc1
    s_cmp_lg_u32 s28, 2
    s_cbranch_scc1 L_n4_192
    s_mov_b64 exec, 1
    s_lshr_b32 s88, s89, 3
    s_add_u32 s88, s88, 4243584
    buffer_store_dwordx4 v[24:27], v2, s[84:87], s88 offen sc1
    s_mov_b64 exec, -1
L_n4_192:
    s_waitcnt lgkmcnt(0)
    s_cmp_lg_u32 s28, 3
    s_cbranch_scc1 L_n7_193
    s_mov_b64 exec, 0xff
    buffer_store_dwordx4 v[8:11], v3, s[84:87], s94 offen sc1
    s_mov_b64 exec, -1
L_n7_193:
    v_mov_b32 v56, 141312
    v_mov_b32 v57, 1
    s_mov_b64 exec, 1
    ds_add_u32 v56, v57 offset:56
    s_mov_b64 exec, -1
    s_waitcnt vmcnt(0)
    v_mov_b32 v24, 141312
L_lw_194:
    ds_read_b32 v25, v24 offset:28
    s_waitcnt lgkmcnt(0)
    v_readfirstlane_b32 s58, v25
    s_cmp_lt_u32 s58, 1
    s_cbranch_scc1 L_lw_194
    s_lshr_b32 s58, s2, 2
    s_lshl_b32 s58, s58, 5
    s_and_b32 s101, s2, 3
    s_add_u32 s58, s58, s101
    s_lshl_b32 s58, s58, 2
    s_add_u32 s58, s58, 188416
    v_mov_b32 v28, 141312
    v_mov_b32 v29, 1
    v_mov_b32 v31, s58
    s_mov_b64 exec, 1
    ds_add_rtn_u32 v29, v28, v29 offset:24
    ds_read_b32 v30, v28 offset:28
    s_waitcnt lgkmcnt(0)
    v_readfirstlane_b32 s58, v29
    v_readfirstlane_b32 s31, v30
    s_cmp_lg_u32 s58, 3
    s_cbranch_scc1 L_na_195
    buffer_store_dword v30, v31, s[24:27], 0 offen sc1
    s_mov_b64 exec, 1
    ds_write_b32 v28, v29 offset:44
L_na_195:
    s_mov_b64 exec, -1
L_k1r_8:
    s_cmp_ge_u32 s30, 28
    s_cbranch_scc1 L_fft_2
    s_and_b32 s58, s29, 1
    s_lshl_b32 s58, s58, 2
    s_and_b32 s57, s30, 3
    s_add_u32 s57, s57, s58
    s_lshl_b32 s57, s57, 11
    s_lshr_b32 s58, s29, 1
    s_mul_i32 s58, s58, 7
    s_lshr_b32 s56, s30, 2
    s_add_u32 s56, s56, s58
    s_lshl_b32 s56, s56, 8
    s_cmp_lt_u32 s28, 4
    s_cbranch_scc1 L_comp_3
    s_and_b32 s70, s28, 3
    s_and_b32 s58, s30, 3
    s_mul_i32 s62, s58, 1
    s_lshr_b32 s58, s30, 2
    s_mul_i32 s58, s58, 1
    s_add_u32 s62, s62, s58
    s_and_b32 s58, s29, 1
    s_mul_i32 s58, s58, 0
    s_add_u32 s62, s62, s58
    s_and_b32 s62, s62, 3
    v_lshrrev_b32 v2, 4, v1
    v_and_b32 v3, 15, v1
    v_lshlrev_b32 v4, 2, v2
    v_xor_b32 v3, v3, v4
    v_lshlrev_b32 v3, 4, v3
    s_lshr_b32 s58, s70, 1
    s_lshl_b32 s58, s58, 5
    v_lshl_add_u32 v5, v2, 6, s58
    s_and_b32 s58, s70, 1
    s_lshl_b32 s58, s58, 9
    s_add_u32 s58, s58, 0
    v_add_u32 v5, s58, v5
    v_mul_u32_u24 v5, 7168, v5
    v_add3_u32 v5, v5, v3, s56
    s_lshr_b32 s58, s70, 1
    s_lshl_b32 s58, s58, 5
    v_lshl_add_u32 v6, v2, 6, s58
    s_and_b32 s58, s70, 1
    s_lshl_b32 s58, s58, 9
    s_add_u32 s58, s58, 1024
    v_add_u32 v6, s58, v6
    v_mul_u32_u24 v6, 7168, v6
    v_add3_u32 v6, v6, v3, s56
    v_subrev_u32 v6, 1024, v6
    s_lshr_b32 s58, s70, 1
    s_lshl_b32 s58, s58, 5
    v_lshl_add_u32 v7, v2, 6, s58
    s_and_b32 s58, s70, 1
    s_lshl_b32 s58, s58, 9
    s_add_u32 s58, s58, 256
    v_add_u32 v7, s58, v7
    v_mul_u32_u24 v7, 7168, v7
    v_add3_u32 v7, v7, v3, s56
    v_subrev_u32 v7, 2048, v7
    s_lshr_b32 s58, s70, 1
    s_lshl_b32 s58, s58, 5
    v_lshl_add_u32 v8, v2, 6, s58
    s_and_b32 s58, s70, 1
    s_lshl_b32 s58, s58, 9
    s_add_u32 s58, s58, 1280
    v_add_u32 v8, s58, v8
    v_mul_u32_u24 v8, 7168, v8
    v_add3_u32 v8, v8, v3, s56
    v_subrev_u32 v8, 3072, v8
    s_mov_b32 s71, 0
    v_lshlrev_b32 v2, 4, v1
    v_add_u32 v2, s57, v2
    s_lshl_b32 s58, s70, 15
    v_add_u32 v9, s58, v2
    v_add_u32 v10, 14336, v9
    s_mov_b32 s71, 0
    s_mov_b32 s72, 0
    s_mov_b32 s73, 0x76543210
    s_add_u32 s58, s71, s62
    s_and_b32 s59, s71, 28
    s_lshr_b32 s59, s73, s59
    s_and_b32 s59, s59, 7
    s_and_b32 s58, s58, 3
    s_lshl2_add_u32 s58, s59, s58
    s_mul_i32 s67, s58, 7168
    s_mul_i32 s68, s58, 131072
    s_lshl_b32 s69, s70, 12
    s_mov_b32 s36, s4
    s_mov_b32 s37, s5
    s_mov_b32 s38, 0xe00000
    s_mov_b32 s39, 0x00020000
    s_mov_b32 s40, s18
    s_mov_b32 s41, s19
    s_mov_b32 s42, 0x400000
    s_mov_b32 s43, 0x00020000
    v_lshlrev_b32 v17, 7, v1
    v_add_u32 v17, 180224, v17
    s_mov_b32 s80, 131072
    v_mov_b32 v15, 141312
    v_mov_b32 v16, 1
    s_cmp_lg_u32 s70, 0
    s_cbranch_scc1 L_np_9
    buffer_load_dwordx4 v[24:27], v17, s[24:27], 0 offen sc1
L_np_9:
    s_cmp_eq_u32 s70, 0
    s_cbranch_scc1 L_np_9a
    s_waitcnt vmcnt(8)
L_np_9a:
    s_waitcnt vmcnt(9)
    s_lshr_b32 s58, s2, 2
    s_lshl_b32 s58, s58, 5
    s_and_b32 s101, s2, 3
    s_add_u32 s58, s58, s101
    s_lshl_b32 s58, s58, 2
    s_add_u32 s58, s58, 200704
    v_mov_b32 v40, 141312
    v_mov_b32 v41, 1
    v_mov_b32 v43, s58
    s_mov_b64 exec, 1
    ds_add_rtn_u32 v41, v40, v41 offset:40
    ds_read_b32 v42, v40 offset:28
    s_waitcnt lgkmcnt(0)
    v_readfirstlane_b32 s58, v41
    s_cmp_lg_u32 s58, 3
    s_cbranch_scc1 L_na_10
    buffer_store_dword v42, v43, s[24:27], 0 offen sc1
L_na_10:
    s_mov_b64 exec, -1
    s_waitcnt vmcnt(0)
    s_cmp_lg_u32 s70, 0
    s_cbranch_scc1 L_ho_13
    s_branch L_hv_15
L_hr_12:
    s_lshr_b32 s58, s68, 16
    s_lshr_b64 s[76:77], s[78:79], s58
    s_and_b32 s58, s76, 3
    s_cmp_eq_u32 s58, 3
    s_cbranch_scc1 L_hs_11
    s_sub_u32 s80, s80, 1
    s_cbranch_scc1 L_hs_11
    s_sleep 2
L_hf_14:
    buffer_load_dwordx4 v[24:27], v17, s[24:27], 0 offen sc1
    s_waitcnt vmcnt(0)
L_hv_15:
    v_xor_b32 v24, s31, v24
    v_xor_b32 v25, s31, v25
    v_xor_b32 v26, s31, v26
    v_xor_b32 v27, s31, v27
    v_or3_b32 v24, v24, v25, v26
    v_or_b32 v24, v24, v27
    v_cmp_eq_u32 s[78:79], 0, v24
    s_branch L_hr_12
L_hs_11:
    s_mov_b64 exec, 1
    ds_add_u32 v15, v16 offset:32
    s_mov_b64 exec, -1
    s_branch L_he_16
L_ho_13:
L_lw_17:
    ds_read_b32 v18, v15 offset:32
    s_waitcnt lgkmcnt(0)
    v_readfirstlane_b32 s58, v18
    s_cmp_lt_u32 s58, 1
    s_cbranch_scc1 L_lw_17
L_he_16:
    s_add_u32 m0, s69, 16384
    s_nop 0
    buffer_load_dwordx4 v9, s[40:43], s68 offen offset:0  lds
    buffer_load_dwordx4 v9, s[40:43], s68 offen offset:1024  lds
    buffer_load_dwordx4 v10, s[40:43], s68 offen offset:2048  lds
    buffer_load_dwordx4 v10, s[40:43], s68 offen offset:3072  lds
    s_add_u32 s71, s71, 1
    s_add_u32 s58, s71, s62
    s_and_b32 s59, s71, 28
    s_lshr_b32 s59, s73, s59
    s_and_b32 s59, s59, 7
    s_and_b32 s58, s58, 3
    s_lshl2_add_u32 s58, s59, s58
    s_mul_i32 s67, s58, 7168
    s_mul_i32 s68, s58, 131072
    s_add_u32 s69, s69, 32768
    s_cmp_ge_u32 s69, 98304
    s_cselect_b32 s58, 98304, 0
    s_sub_u32 s69, s69, s58
    s_cmp_lg_u32 s70, 0
    s_cbranch_scc1 L_ho_21
    s_lshr_b32 s58, s68, 16
    s_lshr_b64 s[76:77], s[78:79], s58
    s_and_b32 s58, s76, 3
    s_cmp_eq_u32 s58, 3
    s_cbranch_scc1 L_hs_19
    s_branch L_hf_22
L_hr_20:
    s_lshr_b32 s58, s68, 16
    s_lshr_b64 s[76:77], s[78:79], s58
    s_and_b32 s58, s76, 3
    s_cmp_eq_u32 s58, 3
    s_cbranch_scc1 L_hs_19
    s_sub_u32 s80, s80, 1
    s_cbranch_scc1 L_hs_19
    s_sleep 2
L_hf_22:
    buffer_load_dwordx4 v[24:27], v17, s[24:27], 0 offen sc1
    s_waitcnt vmcnt(0)
L_hv_23:
    v_xor_b32 v24, s31, v24
    v_xor_b32 v25, s31, v25
    v_xor_b32 v26, s31, v26
    v_xor_b32 v27, s31, v27
    v_or3_b32 v24, v24, v25, v26
    v_or_b32 v24, v24, v27
    v_cmp_eq_u32 s[78:79], 0, v24
    s_branch L_hr_20
L_hs_19:
    s_mov_b64 exec, 1
    ds_add_u32 v15, v16 offset:32
    s_mov_b64 exec, -1
    s_branch L_he_24
L_ho_21:
L_lw_25:
    ds_read_b32 v18, v15 offset:32
    s_waitcnt lgkmcnt(0)
    v_readfirstlane_b32 s58, v18
    s_cmp_lt_u32 s58, 2
    s_cbranch_scc1 L_lw_25
L_he_24:
    s_add_u32 m0, s69, 16384
    s_nop 0
    buffer_load_dwordx4 v9, s[40:43], s68 offen offset:0  lds
    buffer_load_dwordx4 v9, s[40:43], s68 offen offset:1024  lds
    buffer_load_dwordx4 v10, s[40:43], s68 offen offset:2048  lds
    buffer_load_dwordx4 v10, s[40:43], s68 offen offset:3072  lds
    s_add_u32 s71, s71, 1
    s_add_u32 s58, s71, s62
    s_and_b32 s59, s71, 28
    s_lshr_b32 s59, s73, s59
    s_and_b32 s59, s59, 7
    s_and_b32 s58, s58, 3
    s_lshl2_add_u32 s58, s59, s58
    s_mul_i32 s67, s58, 7168
    s_mul_i32 s68, s58, 131072
    s_add_u32 s69, s69, 32768
    s_cmp_ge_u32 s69, 98304
    s_cselect_b32 s58, 98304, 0
    s_sub_u32 s69, s69, s58
    s_cmp_lg_u32 s70, 0
    s_cbranch_scc1 L_hs_27
    s_cmp_eq_u64 s[78:79], -1
    s_cbranch_scc1 L_hs_27
    s_branch L_hf_30
L_hr_28:
    s_cmp_eq_u64 s[78:79], -1
    s_cbranch_scc1 L_hs_27
    s_sub_u32 s80, s80, 1
    s_cbranch_scc1 L_hs_27
    s_sleep 2
L_hf_30:
    buffer_load_dwordx4 v[24:27], v17, s[24:27], 0 offen sc1
    s_waitcnt vmcnt(0)
L_hv_31:
    v_xor_b32 v24, s31, v24
    v_xor_b32 v25, s31, v25
    v_xor_b32 v26, s31, v26
    v_xor_b32 v27, s31, v27
    v_or3_b32 v24, v24, v25, v26
    v_or_b32 v24, v24, v27
    v_cmp_eq_u32 s[78:79], 0, v24
    s_branch L_hr_28
L_hs_27:
    v_and_b32 v14, 31, v1
    v_lshlrev_b32 v14, 2, v14
    s_lshl_b32 s58, s30, 7
    s_add_u32 s58, s58, 135168
    v_add_u32 v14, s58, v14
    v_mov_b32 v15, 141312
    v_mov_b32 v16, 1
    v_mov_b32 v19, s31
    v_and_b32 v144, 31, v1
    v_lshrrev_b32 v145, 5, v1
    v_cvt_f32_u32 v144, v144
    v_cvt_f32_u32 v145, v145
    v_mul_f32 v146, v144, v145
    v_mul_f32 v146, 0x3e000000, v146
    v_fmamk_f32 v128, v144, 0x00000000, v146
    v_fmamk_f32 v129, v144, 0x3d000000, v146
    v_fmamk_f32 v130, v144, 0x3d800000, v146
    v_fmamk_f32 v131, v144, 0x3dc00000, v146
    v_fmamk_f32 v132, v144, 0x3e800000, v146
    v_fmamk_f32 v133, v144, 0x3e900000, v146
    v_fmamk_f32 v134, v144, 0x3ea00000, v146
    v_fmamk_f32 v135, v144, 0x3eb00000, v146
    v_fmamk_f32 v136, v144, 0x3f000000, v146
    v_fmamk_f32 v137, v144, 0x3f080000, v146
    v_fmamk_f32 v138, v144, 0x3f100000, v146
    v_fmamk_f32 v139, v144, 0x3f180000, v146
    v_fmamk_f32 v140, v144, 0x3f400000, v146
    v_fmamk_f32 v141, v144, 0x3f480000, v146
    v_fmamk_f32 v142, v144, 0x3f500000, v146
    v_fmamk_f32 v143, v144, 0x3f580000, v146
    v_cos_f32 v112, v128
    v_sin_f32 v128, v128
    v_cos_f32 v113, v129
    v_sin_f32 v129, v129
    v_cos_f32 v114, v130
    v_sin_f32 v130, v130
    v_cos_f32 v115, v131
    v_sin_f32 v131, v131
    v_cos_f32 v116, v132
    v_sin_f32 v132, v132
    v_cos_f32 v117, v133
    v_sin_f32 v133, v133
    v_cos_f32 v118, v134
    v_sin_f32 v134, v134
    v_cos_f32 v119, v135
    v_sin_f32 v135, v135
    v_cos_f32 v120, v136
    v_sin_f32 v136, v136
    v_cos_f32 v121, v137
    v_sin_f32 v137, v137
    v_cos_f32 v122, v138
    v_sin_f32 v138, v138
    v_cos_f32 v123, v139
    v_sin_f32 v139, v139
    v_cos_f32 v124, v140
    v_sin_f32 v140, v140
    v_cos_f32 v125, v141
    v_sin_f32 v141, v141
    v_cos_f32 v126, v142
    v_sin_f32 v142, v142
    v_cos_f32 v127, v143
    v_sin_f32 v143, v143
    v_cvt_pk_bf16_f32 v56, v112, v113
    v_cvt_pk_bf16_f32 v57, v114, v115
    v_cvt_pk_bf16_f32 v58, v116, v117
    v_cvt_pk_bf16_f32 v59, v118, v119
    v_cvt_pk_bf16_f32 v60, v120, v121
    v_cvt_pk_bf16_f32 v61, v122, v123
    v_cvt_pk_bf16_f32 v62, v124, v125
    v_cvt_pk_bf16_f32 v63, v126, v127
    v_cvt_pk_bf16_f32 v64, v128, v129
    v_cvt_pk_bf16_f32 v65, v130, v131
    v_cvt_pk_bf16_f32 v66, v132, v133
    v_cvt_pk_bf16_f32 v67, v134, v135
    v_cvt_pk_bf16_f32 v68, v136, v137
    v_cvt_pk_bf16_f32 v69, v138, v139
    v_cvt_pk_bf16_f32 v70, v140, v141
    v_cvt_pk_bf16_f32 v71, v142, v143
    v_xor_b32 v72, 0x80008000, v64
    v_xor_b32 v73, 0x80008000, v65
    v_xor_b32 v74, 0x80008000, v66
    v_xor_b32 v75, 0x80008000, v67
    v_xor_b32 v76, 0x80008000, v68
    v_xor_b32 v77, 0x80008000, v69
    v_xor_b32 v78, 0x80008000, v70
    v_xor_b32 v79, 0x80008000, v71
    v_cvt_pk_bf16_f32 v80, v112, -v128
    v_cvt_pk_bf16_f32 v96, v128, v112
    v_cvt_pk_bf16_f32 v81, v113, -v129
    v_cvt_pk_bf16_f32 v97, v129, v113
    v_cvt_pk_bf16_f32 v82, v114, -v130
    v_cvt_pk_bf16_f32 v98, v130, v114
    v_cvt_pk_bf16_f32 v83, v115, -v131
    v_cvt_pk_bf16_f32 v99, v131, v115
    v_cvt_pk_bf16_f32 v84, v116, -v132
    v_cvt_pk_bf16_f32 v100, v132, v116
    v_cvt_pk_bf16_f32 v85, v117, -v133
    v_cvt_pk_bf16_f32 v101, v133, v117
    v_cvt_pk_bf16_f32 v86, v118, -v134
    v_cvt_pk_bf16_f32 v102, v134, v118
    v_cvt_pk_bf16_f32 v87, v119, -v135
    v_cvt_pk_bf16_f32 v103, v135, v119
    v_cvt_pk_bf16_f32 v88, v120, -v136
    v_cvt_pk_bf16_f32 v104, v136, v120
    v_cvt_pk_bf16_f32 v89, v121, -v137
    v_cvt_pk_bf16_f32 v105, v137, v121
    v_cvt_pk_bf16_f32 v90, v122, -v138
    v_cvt_pk_bf16_f32 v106, v138, v122
    v_cvt_pk_bf16_f32 v91, v123, -v139
    v_cvt_pk_bf16_f32 v107, v139, v123
    v_cvt_pk_bf16_f32 v92, v124, -v140
    v_cvt_pk_bf16_f32 v108, v140, v124
    v_cvt_pk_bf16_f32 v93, v125, -v141
    v_cvt_pk_bf16_f32 v109, v141, v125
    v_cvt_pk_bf16_f32 v94, v126, -v142
    v_cvt_pk_bf16_f32 v110, v142, v126
    v_cvt_pk_bf16_f32 v95, v127, -v143
    v_cvt_pk_bf16_f32 v111, v143, v127
    v_mul_f32 v146, v144, v145
    v_mul_f32 v146, 0x3b800000, v146
    v_fmamk_f32 v128, v144, 0x00000000, v146
    v_fmamk_f32 v129, v144, 0x3a800000, v146
    v_fmamk_f32 v130, v144, 0x3b000000, v146
    v_fmamk_f32 v131, v144, 0x3b400000, v146
    v_fmamk_f32 v132, v144, 0x3c000000, v146
    v_fmamk_f32 v133, v144, 0x3c100000, v146
    v_fmamk_f32 v134, v144, 0x3c200000, v146
    v_fmamk_f32 v135, v144, 0x3c300000, v146
    v_fmamk_f32 v136, v144, 0x3c800000, v146
    v_fmamk_f32 v137, v144, 0x3c880000, v146
    v_fmamk_f32 v138, v144, 0x3c900000, v146
    v_fmamk_f32 v139, v144, 0x3c980000, v146
    v_fmamk_f32 v140, v144, 0x3cc00000, v146
    v_fmamk_f32 v141, v144, 0x3cc80000, v146
    v_fmamk_f32 v142, v144, 0x3cd00000, v146
    v_fmamk_f32 v143, v144, 0x3cd80000, v146
    v_cos_f32 v112, v128
    v_sin_f32 v128, v128
    v_cos_f32 v113, v129
    v_sin_f32 v129, v129
    v_cos_f32 v114, v130
    v_sin_f32 v130, v130
    v_cos_f32 v115, v131
    v_sin_f32 v131, v131
    v_cos_f32 v116, v132
    v_sin_f32 v132, v132
    v_cos_f32 v117, v133
    v_sin_f32 v133, v133
    v_cos_f32 v118, v134
    v_sin_f32 v134, v134
    v_cos_f32 v119, v135
    v_sin_f32 v135, v135
    v_cos_f32 v120, v136
    v_sin_f32 v136, v136
    v_cos_f32 v121, v137
    v_sin_f32 v137, v137
    v_cos_f32 v122, v138
    v_sin_f32 v138, v138
    v_cos_f32 v123, v139
    v_sin_f32 v139, v139
    v_cos_f32 v124, v140
    v_sin_f32 v140, v140
    v_cos_f32 v125, v141
    v_sin_f32 v141, v141
    v_cos_f32 v126, v142
    v_sin_f32 v142, v142
    v_cos_f32 v127, v143
    v_sin_f32 v143, v143
    v_mul_f32 v112, 0x35000000, v112
    v_mul_f32 v128, 0x35000000, v128
    v_mul_f32 v113, 0x35000000, v113
    v_mul_f32 v129, 0x35000000, v129
    v_mul_f32 v114, 0x35000000, v114
    v_mul_f32 v130, 0x35000000, v130
    v_mul_f32 v115, 0x35000000, v115
    v_mul_f32 v131, 0x35000000, v131
    v_mul_f32 v116, 0x35000000, v116
    v_mul_f32 v132, 0x35000000, v132
    v_mul_f32 v117, 0x35000000, v117
    v_mul_f32 v133, 0x35000000, v133
    v_mul_f32 v118, 0x35000000, v118
    v_mul_f32 v134, 0x35000000, v134
    v_mul_f32 v119, 0x35000000, v119
    v_mul_f32 v135, 0x35000000, v135
    v_mul_f32 v120, 0x35000000, v120
    v_mul_f32 v136, 0x35000000, v136
    v_mul_f32 v121, 0x35000000, v121
    v_mul_f32 v137, 0x35000000, v137
    v_mul_f32 v122, 0x35000000, v122
    v_mul_f32 v138, 0x35000000, v138
    v_mul_f32 v123, 0x35000000, v123
    v_mul_f32 v139, 0x35000000, v139
    v_mul_f32 v124, 0x35000000, v124
    v_mul_f32 v140, 0x35000000, v140
    v_mul_f32 v125, 0x35000000, v125
    v_mul_f32 v141, 0x35000000, v141
    v_mul_f32 v126, 0x35000000, v126
    v_mul_f32 v142, 0x35000000, v142
    v_mul_f32 v127, 0x35000000, v127
    v_mul_f32 v143, 0x35000000, v143
    s_waitcnt vmcnt(4)
    s_barrier
    s_lshr_b32 s58, s29, 2
    s_lshl_b32 s58, s58, 5
    s_add_u32 s81, s30, s58
    s_and_b32 s58, s29, 3
    s_lshl_b32 s58, s58, 8
    s_add_u32 s81, s81, s58
    s_lshl_b32 s58, s70, 6
    s_add_u32 s81, s81, s58
    s_lshl_b32 s81, s81, 11
    s_add_u32 s82, s81, 2097152
    v_and_b32 v2, 31, v1
    v_lshrrev_b32 v3, 5, v1
    v_lshlrev_b32 v11, 6, v2
    v_lshl_add_u32 v11, v3, 4, v11
    s_mov_b32 s44, s12
    s_mov_b32 s45, s13
    s_mov_b32 s46, 0x400000
    s_mov_b32 s47, 0x00020000
    buffer_load_dwordx4 v[176:179], v11, s[44:47], s81 offen offset:0
    buffer_load_dwordx4 v[180:183], v11, s[44:47], s81 offen offset:32
    buffer_load_dwordx4 v[184:187], v11, s[44:47], s82 offen offset:0
    buffer_load_dwordx4 v[188:191], v11, s[44:47], s82 offen offset:32
    s_mov_b32 m0, s69
    s_nop 0
    buffer_load_dwordx4 v5, s[36:39], s67 offen offset:0  lds
    buffer_load_dwordx4 v6, s[36:39], s67 offen offset:1024  lds
    buffer_load_dwordx4 v7, s[36:39], s67 offen offset:2048  lds
    buffer_load_dwordx4 v8, s[36:39], s67 offen offset:3072  lds
    s_add_u32 m0, s69, 16384
    s_nop 0
    buffer_load_dwordx4 v9, s[40:43], s68 offen offset:0  lds
    buffer_load_dwordx4 v9, s[40:43], s68 offen offset:1024  lds
    buffer_load_dwordx4 v10, s[40:43], s68 offen offset:2048  lds
    buffer_load_dwordx4 v10, s[40:43], s68 offen offset:3072  lds
    s_add_u32 s71, s71, 1
    s_add_u32 s58, s71, s62
    s_and_b32 s59, s71, 28
    s_lshr_b32 s59, s73, s59
    s_and_b32 s59, s59, 7
    s_and_b32 s58, s58, 3
    s_lshl2_add_u32 s58, s59, s58
    s_mul_i32 s67, s58, 7168
    s_mul_i32 s68, s58, 131072
    s_add_u32 s69, s69, 32768
    s_cmp_ge_u32 s69, 98304
    s_cselect_b32 s58, 98304, 0
    s_sub_u32 s69, s69, s58
    s_waitcnt vmcnt(12)
    s_barrier
    s_mov_b32 m0, s69
    s_nop 0
    buffer_load_dwordx4 v5, s[36:39], s67 offen offset:0  lds
    buffer_load_dwordx4 v6, s[36:39], s67 offen offset:1024  lds
    buffer_load_dwordx4 v7, s[36:39], s67 offen offset:2048  lds
    buffer_load_dwordx4 v8, s[36:39], s67 offen offset:3072  lds
    s_add_u32 m0, s69, 16384
    s_nop 0
    buffer_load_dwordx4 v9, s[40:43], s68 offen offset:0  lds
    buffer_load_dwordx4 v9, s[40:43], s68 offen offset:1024  lds
    buffer_load_dwordx4 v10, s[40:43], s68 offen offset:2048  lds
    buffer_load_dwordx4 v10, s[40:43], s68 offen offset:3072  lds
    s_add_u32 s71, s71, 1
    s_add_u32 s58, s71, s62
    s_and_b32 s59, s71, 28
    s_lshr_b32 s59, s73, s59
    s_and_b32 s59, s59, 7
    s_and_b32 s58, s58, 3
    s_lshl2_add_u32 s58, s59, s58
    s_mul_i32 s67, s58, 7168
    s_mul_i32 s68, s58, 131072
    s_add_u32 s69, s69, 32768
    s_cmp_ge_u32 s69, 98304
    s_cselect_b32 s58, 98304, 0
    s_sub_u32 s69, s69, s58
    s_mov_b32 s66, 27
L_lloop_34:
    s_waitcnt vmcnt(8)
    s_barrier
    s_mov_b32 m0, s69
    s_nop 0
    buffer_load_dwordx4 v5, s[36:39], s67 offen offset:0  lds
    buffer_load_dwordx4 v6, s[36:39], s67 offen offset:1024  lds
    buffer_load_dwordx4 v7, s[36:39], s67 offen offset:2048  lds
    buffer_load_dwordx4 v8, s[36:39], s67 offen offset:3072  lds
    s_add_u32 m0, s69, 16384
    s_nop 0
    buffer_load_dwordx4 v9, s[40:43], s68 offen offset:0  lds
    buffer_load_dwordx4 v9, s[40:43], s68 offen offset:1024  lds
    buffer_load_dwordx4 v10, s[40:43], s68 offen offset:2048  lds
    buffer_load_dwordx4 v10, s[40:43], s68 offen offset:3072  lds
    s_add_u32 s71, s71, 1
    s_add_u32 s58, s71, s62
    s_and_b32 s59, s71, 28
    s_lshr_b32 s59, s73, s59
    s_and_b32 s59, s59, 7
    s_and_b32 s58, s58, 3
    s_lshl2_add_u32 s58, s59, s58
    s_mul_i32 s67, s58, 7168
    s_mul_i32 s68, s58, 131072
    s_add_u32 s69, s69, 32768
    s_cmp_ge_u32 s69, 98304
    s_cselect_b32 s58, 98304, 0
    s_sub_u32 s69, s69, s58
    s_sub_u32 s66, s66, 1
    s_cmp_lg_u32 s66, 0
    s_cbranch_scc1 L_lloop_34
    s_waitcnt vmcnt(8)
    s_barrier
    s_cmp_lg_u32 s70, 0
    s_cbranch_scc1 L_np_36
    buffer_load_dword v18, v14, s[24:27], 0 offen sc1
L_np_36:
    s_mov_b32 m0, s69
    s_nop 0
    buffer_load_dwordx4 v5, s[36:39], s67 offen offset:0  lds
    buffer_load_dwordx4 v6, s[36:39], s67 offen offset:1024  lds
    buffer_load_dwordx4 v7, s[36:39], s67 offen offset:2048  lds
    buffer_load_dwordx4 v8, s[36:39], s67 offen offset:3072  lds
    s_add_u32 m0, s69, 16384
    s_nop 0
    buffer_load_dwordx4 v9, s[40:43], s68 offen offset:0  lds
    buffer_load_dwordx4 v9, s[40:43], s68 offen offset:1024  lds
    buffer_load_dwordx4 v10, s[40:43], s68 offen offset:2048  lds
    buffer_load_dwordx4 v10, s[40:43], s68 offen offset:3072  lds
    s_add_u32 s71, s71, 1
    s_add_u32 s58, s71, s62
    s_and_b32 s59, s71, 28
    s_lshr_b32 s59, s73, s59
    s_and_b32 s59, s59, 7
    s_and_b32 s58, s58, 3
    s_lshl2_add_u32 s58, s59, s58
    s_mul_i32 s67, s58, 7168
    s_mul_i32 s68, s58, 131072
    s_add_u32 s69, s69, 32768
    s_cmp_ge_u32 s69, 98304
    s_cselect_b32 s58, 98304, 0
    s_sub_u32 s69, s69, s58
    s_and_b32 s58, s29, 1
    s_lshl_b32 s58, s58, 2
    s_and_b32 s57, s30, 3
    s_add_u32 s57, s57, s58
    s_lshl_b32 s57, s57, 11
    s_bfe_u32 s63, s2, 0x10002
    s_bfe_u32 s58, s2, 0x10001
    s_lshl_b32 s58, s58, 3
    s_lshr_b32 s56, s30, 2
    s_add_u32 s56, s56, s58
    s_lshl_b32 s56, s56, 8
    s_mul_i32 s64, s63, 7340032
    s_add_u32 s64, s64, s56
    s_mul_i32 s65, s63, 3670016
    s_add_u32 s65, s65, s57
    s_and_b32 s58, s30, 3
    s_mul_i32 s62, s58, 1
    s_lshr_b32 s58, s30, 2
    s_mul_i32 s58, s58, 1
    s_add_u32 s62, s62, s58
    s_and_b32 s58, s29, 1
    s_mul_i32 s58, s58, 0
    s_add_u32 s62, s62, s58
    s_and_b32 s62, s62, 3
    v_lshrrev_b32 v2, 4, v1
    v_and_b32 v3, 15, v1
    v_lshlrev_b32 v4, 2, v2
    v_xor_b32 v3, v3, v4
    v_lshlrev_b32 v3, 4, v3
    s_lshl_b32 s58, s70, 4
    s_add_u32 s58, s58, 0
    v_add_u32 v5, s58, v2
    v_lshlrev_b32 v5, 12, v5
    v_add3_u32 v5, v5, v3, s64
    s_lshl_b32 s58, s70, 4
    s_add_u32 s58, s58, 8
    v_add_u32 v6, s58, v2
    v_lshlrev_b32 v6, 12, v6
    v_add3_u32 v6, v6, v3, s64
    v_subrev_u32 v6, 1024, v6
    s_lshl_b32 s58, s70, 4
    s_add_u32 s58, s58, 4
    v_add_u32 v7, s58, v2
    v_lshlrev_b32 v7, 12, v7
    v_add3_u32 v7, v7, v3, s64
    v_subrev_u32 v7, 2048, v7
    s_lshl_b32 s58, s70, 4
    s_add_u32 s58, s58, 12
    v_add_u32 v8, s58, v2
    v_lshlrev_b32 v8, 12, v8
    v_add3_u32 v8, v8, v3, s64
    v_subrev_u32 v8, 3072, v8
    s_mov_b32 s71, 0
    v_lshlrev_b32 v2, 4, v1
    v_add_u32 v2, s65, v2
    s_lshl_b32 s58, s70, 15
    v_add_u32 v9, s58, v2
    v_add_u32 v10, 14336, v9
    s_mov_b32 s71, 0
    s_mov_b32 s72, 0
    s_mov_b32 s73, 0x6543210
    s_mov_b32 s58, 0x5461032
    s_bitcmp1_b32 s29, 0
    s_cselect_b32 s73, s58, s73
    s_mov_b32 s71, -1
    s_mov_b64 s[78:79], 0
    s_mov_b32 s80, 131072
    s_lshr_b32 s58, s57, 10
    s_add_u32 s58, s58, s63
    s_lshl_b32 s58, s58, 11
    s_add_u32 s58, s58, 147456
    v_min_u32 v17, 13, v1
    v_lshl_add_u32 v17, v17, 7, s58
    v_lshrrev_b32 v2, 1, v1
    s_lshl_b32 s58, s70, 7
    v_add_u32 v2, s58, v2
    v_mul_u32_u24 v2, 8320, v2
    v_and_b32 v3, 1, v1
    v_lshl_add_u32 v4, v3, 4, v2
    s_lshl_b32 s58, s29, 5
    s_add_u32 s83, s30, s58
    s_lshl_b32 s83, s83, 5
    s_add_u32 s84, s83, 265216
    s_add_u32 s85, s83, 530432
    s_add_u32 s86, s83, 795648
    v_and_b32 v2, 31, v1
    v_lshrrev_b32 v3, 5, v1
    v_lshl_add_u32 v2, v3, 7, v2
    v_lshlrev_b32 v2, 5, v2
    s_lshl_b32 s58, s70, 2
    s_add_u32 s58, s58, 98304
    v_add_u32 v12, s58, v2
    s_add_u32 s58, s58, 5136
    v_sub_u32 v13, s58, v2
    s_mov_b32 s36, s8
    s_mov_b32 s37, s9
    s_mov_b32 s38, 0xe00000
    s_mov_b32 s39, 0x00020000
    s_add_u32 s48, s18, 0x2000000
    s_addc_u32 s49, s19, 0
    s_mov_b32 s50, 0x412080
    s_mov_b32 s51, 0x00020000
    s_add_u32 s52, s18, 0x2800000
    s_addc_u32 s53, s19, 0
    s_mov_b32 s54, 0x400000
    s_mov_b32 s55, 0x00020000
    s_lshl_b32 s58, s29, 2
    s_add_u32 s58, s58, s70
    s_lshl_b32 s58, s58, 5
    s_add_u32 s58, s58, s30
    s_lshl_b32 s58, s58, 2
    s_add_u32 s58, s58, 139264
    v_mov_b32 v2, s58
    s_bfe_u32 s58, s2, 0x10001
    s_mul_i32 s58, s58, 7
    s_lshr_b32 s74, s30, 2
    s_add_u32 s74, s74, s58
    s_mul_i32 s67, s74, 524288
    s_waitcnt vmcnt(8)
    s_cmp_lg_u32 s70, 0
    s_cbranch_scc1 L_np_38
    v_cmp_ne_u32 vcc, s31, v18
    s_cmp_lg_u64 vcc, 0
    s_cbranch_scc1 L_np_38
    s_mov_b64 exec, 1
    ds_add_u32 v15, v16 offset:4
    s_mov_b64 exec, -1
    s_waitcnt lgkmcnt(0)
L_np_38:
    s_barrier
    ds_read_b32 v18, v15 offset:4
    s_mov_b32 m0, s69
    s_nop 0
    buffer_load_dwordx4 v5, s[36:39], s67 offen offset:0  lds
    buffer_load_dwordx4 v6, s[36:39], s67 offen offset:1024  lds
    buffer_load_dwordx4 v7, s[36:39], s67 offen offset:2048  lds
    buffer_load_dwordx4 v8, s[36:39], s67 offen offset:3072  lds
    s_add_u32 s69, s69, 32768
    s_cmp_ge_u32 s69, 98304
    s_cselect_b32 s58, 98304, 0
    s_sub_u32 s69, s69, s58
    s_add_u32 s67, s67, 262144
    s_waitcnt lgkmcnt(0)
    v_readfirstlane_b32 s58, v18
    s_cmp_eq_u32 s58, 0
    s_cbranch_scc1 L_late_39
    s_lshl_b32 s58, s70, 2
    s_add_u32 s58, s58, 114704
    v_mov_b32 v40, s58
    v_mov_b32 v41, 0
    ds_write_b32 v40, v41
    s_add_u32 s58, s58, s83
    s_add_u32 s58, s58, 4145152
    v_mov_b32 v20, s58
    s_lshl_b32 s58, s70, 12
    s_add_u32 s84, s58, 98304
    s_lshl_b32 s58, s30, 7
    s_add_u32 s58, s58, 208896
    v_mov_b32 v21, s58
    s_mov_b32 m0, s84
    s_mov_b32 s58, s83
    buffer_load_dwordx4 v4, s[48:51], s58 offen offset:0  lds
    s_add_u32 s58, s58, 265216
    buffer_load_dwordx4 v4, s[48:51], s58 offen offset:1024  lds
    s_add_u32 s58, s58, 265216
    buffer_load_dwordx4 v4, s[48:51], s58 offen offset:2048  lds
    s_add_u32 s58, s58, 265216
    buffer_load_dwordx4 v4, s[48:51], s58 offen offset:3072  lds
    s_waitcnt vmcnt(8)
    s_barrier
    s_mov_b32 m0, s69
    s_nop 0
    buffer_load_dwordx4 v5, s[36:39], s67 offen offset:0  lds
    buffer_load_dwordx4 v6, s[36:39], s67 offen offset:1024  lds
    buffer_load_dwordx4 v7, s[36:39], s67 offen offset:2048  lds
    buffer_load_dwordx4 v8, s[36:39], s67 offen offset:3072  lds
L_kn_41:
    s_add_u32 s71, s71, 1
    s_add_u32 s58, s71, s62
    s_and_b32 s59, s71, 28
    s_lshr_b32 s59, s73, s59
    s_and_b32 s59, s59, 7
    s_and_b32 s58, s58, 3
    s_lshl2_add_u32 s58, s59, s58
    s_lshr_b32 s75, s58, 1
    s_cmp_eq_u32 s75, s74
    s_cbranch_scc1 L_kn_41
    s_mul_i32 s67, s58, 262144
    s_mul_i32 s68, s58, 131072
    s_add_u32 s69, s69, 32768
    s_cmp_ge_u32 s69, 98304
    s_cselect_b32 s58, 98304, 0
    s_sub_u32 s69, s69, s58
    s_barrier
    s_add_u32 s40, s18, 0x1800000
    s_addc_u32 s41, s19, 0
    s_mov_b32 s42, 0x700000
    s_mov_b32 s43, 0x00020000
    s_branch L_t1_40
L_late_39:
    s_waitcnt vmcnt(4)
    s_barrier
    s_mov_b32 m0, s69
    s_nop 0
    buffer_load_dwordx4 v5, s[36:39], s67 offen offset:0  lds
    buffer_load_dwordx4 v6, s[36:39], s67 offen offset:1024  lds
    buffer_load_dwordx4 v7, s[36:39], s67 offen offset:2048  lds
    buffer_load_dwordx4 v8, s[36:39], s67 offen offset:3072  lds
L_kn_42:
    s_add_u32 s71, s71, 1
    s_add_u32 s58, s71, s62
    s_and_b32 s59, s71, 28
    s_lshr_b32 s59, s73, s59
    s_and_b32 s59, s59, 7
    s_and_b32 s58, s58, 3
    s_lshl2_add_u32 s58, s59, s58
    s_lshr_b32 s75, s58, 1
    s_cmp_eq_u32 s75, s74
    s_cbranch_scc1 L_kn_42
    s_mul_i32 s67, s58, 262144
    s_mul_i32 s68, s58, 131072
    s_add_u32 s69, s69, 32768
    s_cmp_ge_u32 s69, 98304
    s_cselect_b32 s58, 98304, 0
    s_sub_u32 s69, s69, s58
    s_barrier
    s_add_u32 s40, s18, 0x1800000
    s_addc_u32 s41, s19, 0
    s_mov_b32 s42, 0x700000
    s_mov_b32 s43, 0x00020000
L_seamL_4:
    s_cmp_lg_u32 s70, 0
    s_cbranch_scc1 L_np_43
    s_mov_b32 s66, 131072
    s_branch L_poll_44x
L_poll_44:
    s_sleep 4
L_poll_44x:
    buffer_load_dword v24, v14, s[24:27], 0 offen sc1
L_pollw_45:
    s_waitcnt vmcnt(0)
    v_cmp_ne_u32 vcc, s31, v24
    s_sub_u32 s66, s66, 1
    s_cbranch_scc1 L_polld_46
    s_cmp_lg_u64 vcc, 0
    s_cbranch_scc1 L_poll_44
L_polld_46:
    s_mov_b64 exec, 1
    ds_add_u32 v15, v16 offset:4
    s_mov_b64 exec, -1
L_np_43:
L_lw_47:
    ds_read_b32 v18, v15 offset:4
    s_waitcnt lgkmcnt(0)
    v_readfirstlane_b32 s58, v18
    s_cmp_lt_u32 s58, 1
    s_cbranch_scc1 L_lw_47
    s_lshl_b32 s58, s70, 2
    s_add_u32 s58, s58, 114704
    v_mov_b32 v40, s58
    v_mov_b32 v41, 0
    ds_write_b32 v40, v41
    s_add_u32 s58, s58, s83
    s_add_u32 s58, s58, 4145152
    v_mov_b32 v20, s58
    s_lshl_b32 s58, s70, 12
    s_add_u32 s84, s58, 98304
    s_lshl_b32 s58, s30, 7
    s_add_u32 s58, s58, 208896
    v_mov_b32 v21, s58
    s_mov_b32 m0, s84
    s_mov_b32 s58, s83
    buffer_load_dwordx4 v4, s[48:51], s58 offen offset:0  lds
    s_add_u32 s58, s58, 265216
    buffer_load_dwordx4 v4, s[48:51], s58 offen offset:1024  lds
    s_add_u32 s58, s58, 265216
    buffer_load_dwordx4 v4, s[48:51], s58 offen offset:2048  lds
    s_add_u32 s58, s58, 265216
    buffer_load_dwordx4 v4, s[48:51], s58 offen offset:3072  lds
L_t1_40:
    s_waitcnt vmcnt(8)
    s_cmp_eq_u32 s74, 99
    s_cbranch_scc1 L_f0_48
    s_barrier
L_f1_49:
    s_mov_b32 m0, s69
    s_nop 0
    buffer_load_dwordx4 v5, s[36:39], s67 offen offset:0  lds
    buffer_load_dwordx4 v6, s[36:39], s67 offen offset:1024  lds
    buffer_load_dwordx4 v7, s[36:39], s67 offen offset:2048  lds
    buffer_load_dwordx4 v8, s[36:39], s67 offen offset:3072  lds
    s_mov_b32 s96, s69
    s_mov_b32 s97, s68
    s_mov_b32 s98, s75
L_kn_50:
    s_add_u32 s71, s71, 1
    s_add_u32 s58, s71, s62
    s_and_b32 s59, s71, 28
    s_lshr_b32 s59, s73, s59
    s_and_b32 s59, s59, 7
    s_and_b32 s58, s58, 3
    s_lshl2_add_u32 s58, s59, s58
    s_lshr_b32 s75, s58, 1
    s_cmp_eq_u32 s75, s74
    s_cbranch_scc1 L_kn_50
    s_mul_i32 s67, s58, 262144
    s_mul_i32 s68, s58, 131072
    s_add_u32 s69, s69, 32768
    s_cmp_ge_u32 s69, 98304
    s_cselect_b32 s58, 98304, 0
    s_sub_u32 s69, s69, s58
    s_waitcnt vmcnt(4)
    s_barrier
    s_mov_b32 m0, s69
    s_nop 0
    buffer_load_dwordx4 v5, s[36:39], s67 offen offset:0  lds
    buffer_load_dwordx4 v6, s[36:39], s67 offen offset:1024  lds
    buffer_load_dwordx4 v7, s[36:39], s67 offen offset:2048  lds
    buffer_load_dwordx4 v8, s[36:39], s67 offen offset:3072  lds
    s_cmp_eq_u32 s74, 99
    s_cbranch_scc1 L_sk_51
    ds_read_b32 v24, v12 offset:0
    ds_read_b32 v25, v12 offset:1024
    ds_read_b32 v26, v12 offset:2048
    ds_read_b32 v27, v12 offset:3072
    ds_read_b32 v28, v12 offset:8192
    ds_read_b32 v29, v12 offset:9216
    ds_read_b32 v30, v12 offset:10240
    ds_read_b32 v31, v12 offset:11264
    ds_read_b32 v32, v13 offset:11264
    ds_read_b32 v33, v13 offset:10240
    ds_read_b32 v34, v13 offset:9216
    ds_read_b32 v35, v13 offset:8192
    s_waitcnt lgkmcnt(8)
    ds_read_b32 v36, v13 offset:3072
    ds_read_b32 v37, v13 offset:2048
    ds_read_b32 v38, v13 offset:1024
    ds_read_b32 v39, v13 offset:0
    v_permlane32_swap_b32 v176, v178
    v_permlane32_swap_b32 v177, v179
    v_permlane32_swap_b32 v180, v182
    v_permlane32_swap_b32 v181, v183
    v_permlane32_swap_b32 v184, v186
    v_permlane32_swap_b32 v185, v187
    v_permlane32_swap_b32 v188, v190
    v_permlane32_swap_b32 v189, v191
    v_mfma_f32_32x32x16_bf16 v[144:159], v[24:27], v[80:83], 0
    v_mfma_f32_32x32x16_bf16 v[160:175], v[24:27], v[96:99], 0
    s_waitcnt lgkmcnt(8)
    v_mfma_f32_32x32x16_bf16 v[144:159], v[28:31], v[84:87], v[144:159]
    v_mfma_f32_32x32x16_bf16 v[160:175], v[28:31], v[100:103], v[160:175]
    s_waitcnt lgkmcnt(4)
    v_mfma_f32_32x32x16_bf16 v[144:159], v[32:35], v[88:91], v[144:159]
    v_mfma_f32_32x32x16_bf16 v[160:175], v[32:35], v[104:107], v[160:175]
    s_waitcnt lgkmcnt(0)
    v_mfma_f32_32x32x16_bf16 v[144:159], v[36:39], v[92:95], v[144:159]
    v_mfma_f32_32x32x16_bf16 v[160:175], v[36:39], v[108:111], v[160:175]
    s_nop 10
    v_mul_f32 v40, v144, v128
    v_mul_f32 v41, v145, v129
    v_mul_f32 v42, v146, v130
    v_mul_f32 v43, v147, v131
    v_mul_f32 v44, v148, v132
    v_mul_f32 v45, v149, v133
    v_mul_f32 v46, v150, v134
    v_mul_f32 v47, v151, v135
    v_mul_f32 v48, v152, v136
    v_mul_f32 v49, v153, v137
    v_mul_f32 v50, v154, v138
    v_mul_f32 v51, v155, v139
    v_mul_f32 v52, v156, v140
    v_mul_f32 v53, v157, v141
    v_mul_f32 v54, v158, v142
    v_mul_f32 v55, v159, v143
    v_mul_f32 v144, v144, v112
    v_mul_f32 v145, v145, v113
    v_mul_f32 v146, v146, v114
    v_mul_f32 v147, v147, v115
    v_mul_f32 v148, v148, v116
    v_mul_f32 v149, v149, v117
    v_mul_f32 v150, v150, v118
    v_mul_f32 v151, v151, v119
    v_mul_f32 v152, v152, v120
    v_mul_f32 v153, v153, v121
    v_mul_f32 v154, v154, v122
    v_mul_f32 v155, v155, v123
    v_mul_f32 v156, v156, v124
    v_mul_f32 v157, v157, v125
    v_mul_f32 v158, v158, v126
    v_mul_f32 v159, v159, v127
    v_fma_f32 v144, -v160, v128, v144
    v_fma_f32 v145, -v161, v129, v145
    v_fma_f32 v146, -v162, v130, v146
    v_fma_f32 v147, -v163, v131, v147
    v_fma_f32 v148, -v164, v132, v148
    v_fma_f32 v149, -v165, v133, v149
    v_fma_f32 v150, -v166, v134, v150
    v_fma_f32 v151, -v167, v135, v151
    v_fma_f32 v152, -v168, v136, v152
    v_fma_f32 v153, -v169, v137, v153
    v_fma_f32 v154, -v170, v138, v154
    v_fma_f32 v155, -v171, v139, v155
    v_fma_f32 v156, -v172, v140, v156
    v_fma_f32 v157, -v173, v141, v157
    v_fma_f32 v158, -v174, v142, v158
    v_fma_f32 v159, -v175, v143, v159
    v_fma_f32 v160, v160, v112, v40
    v_fma_f32 v161, v161, v113, v41
    v_fma_f32 v162, v162, v114, v42
    v_fma_f32 v163, v163, v115, v43
    v_fma_f32 v164, v164, v116, v44
    v_fma_f32 v165, v165, v117, v45
    v_fma_f32 v166, v166, v118, v46
    v_fma_f32 v167, v167, v119, v47
    v_fma_f32 v168, v168, v120, v48
    v_fma_f32 v169, v169, v121, v49
    v_fma_f32 v170, v170, v122, v50
    v_fma_f32 v171, v171, v123, v51
    v_fma_f32 v172, v172, v124, v52
    v_fma_f32 v173, v173, v125, v53
    v_fma_f32 v174, v174, v126, v54
    v_fma_f32 v175, v175, v127, v55
    v_cvt_pk_bf16_f32 v24, v144, v145
    v_cvt_pk_bf16_f32 v25, v146, v147
    v_cvt_pk_bf16_f32 v26, v148, v149
    v_cvt_pk_bf16_f32 v27, v150, v151
    v_cvt_pk_bf16_f32 v28, v152, v153
    v_cvt_pk_bf16_f32 v29, v154, v155
    v_cvt_pk_bf16_f32 v30, v156, v157
    v_cvt_pk_bf16_f32 v31, v158, v159
    v_cvt_pk_bf16_f32 v32, v160, v161
    v_cvt_pk_bf16_f32 v33, v162, v163
    v_cvt_pk_bf16_f32 v34, v164, v165
    v_cvt_pk_bf16_f32 v35, v166, v167
    v_cvt_pk_bf16_f32 v36, v168, v169
    v_cvt_pk_bf16_f32 v37, v170, v171
    v_cvt_pk_bf16_f32 v38, v172, v173
    v_cvt_pk_bf16_f32 v39, v174, v175
    s_cmp_lg_u32 s70, 0
    s_cbranch_scc1 L_pp_52
    buffer_load_dword v18, v17, s[24:27], 0 offen sc1
L_pp_52:
    v_lshlrev_b32 v144, 16, v176
    v_and_b32 v145, 0xffff0000, v176
    v_lshlrev_b32 v146, 16, v177
    v_and_b32 v147, 0xffff0000, v177
    v_lshlrev_b32 v148, 16, v178
    v_and_b32 v149, 0xffff0000, v178
    v_lshlrev_b32 v150, 16, v179
    v_and_b32 v151, 0xffff0000, v179
    v_lshlrev_b32 v152, 16, v180
    v_and_b32 v153, 0xffff0000, v180
    v_lshlrev_b32 v154, 16, v181
    v_and_b32 v155, 0xffff0000, v181
    v_lshlrev_b32 v156, 16, v182
    v_and_b32 v157, 0xffff0000, v182
    v_lshlrev_b32 v158, 16, v183
    v_and_b32 v159, 0xffff0000, v183
    v_lshlrev_b32 v160, 16, v184
    v_and_b32 v161, 0xffff0000, v184
    v_lshlrev_b32 v162, 16, v185
    v_and_b32 v163, 0xffff0000, v185
    v_lshlrev_b32 v164, 16, v186
    v_and_b32 v165, 0xffff0000, v186
    v_lshlrev_b32 v166, 16, v187
    v_and_b32 v167, 0xffff0000, v187
    v_lshlrev_b32 v168, 16, v188
    v_and_b32 v169, 0xffff0000, v188
    v_lshlrev_b32 v170, 16, v189
    v_and_b32 v171, 0xffff0000, v189
    v_lshlrev_b32 v172, 16, v190
    v_and_b32 v173, 0xffff0000, v190
    v_lshlrev_b32 v174, 16, v191
    v_and_b32 v175, 0xffff0000, v191
    v_mfma_f32_32x32x16_bf16 v[144:159], v[24:27], v[56:59], v[144:159]
    s_nop 0
    v_mfma_f32_32x32x16_bf16 v[160:175], v[32:35], v[56:59], v[160:175]
    v_mfma_f32_32x32x16_bf16 v[144:159], v[32:35], v[72:75], v[144:159]
    v_mfma_f32_32x32x16_bf16 v[160:175], v[24:27], v[64:67], v[160:175]
    v_mfma_f32_32x32x16_bf16 v[144:159], v[28:31], v[60:63], v[144:159]
    v_mfma_f32_32x32x16_bf16 v[160:175], v[36:39], v[60:63], v[160:175]
    v_mfma_f32_32x32x16_bf16 v[144:159], v[36:39], v[76:79], v[144:159]
    v_mfma_f32_32x32x16_bf16 v[160:175], v[28:31], v[68:71], v[160:175]
    s_cmp_lg_u32 s70, 0
    s_cbranch_scc1 L_pp_53
    s_waitcnt vmcnt(0)
    v_cmp_eq_u32 s[78:79], s31, v18
L_pp_53:
L_sk_51:
    s_cmp_lg_u32 s70, 0
    s_cbranch_scc1 L_no_56
    s_bitcmp1_b32 s78, s98
    s_cbranch_scc1 L_ns_54
    s_branch L_nf_57
L_nr_55:
    s_bitcmp1_b32 s78, s98
    s_cbranch_scc1 L_ns_54
    s_sub_u32 s80, s80, 1
    s_cbranch_scc1 L_ns_54
    s_sleep 2
L_nf_57:
    buffer_load_dword v18, v17, s[24:27], 0 offen sc1
    s_waitcnt vmcnt(0)
    v_cmp_eq_u32 s[78:79], s31, v18
    s_branch L_nr_55
L_ns_54:
    s_mov_b64 exec, 1
    ds_add_u32 v15, v16 offset:0
    s_mov_b64 exec, -1
    s_branch L_ne_58
L_no_56:
L_lw_59:
    ds_read_b32 v18, v15 offset:0
    s_waitcnt lgkmcnt(0)
    v_readfirstlane_b32 s58, v18
    s_cmp_lt_u32 s58, 1
    s_cbranch_scc1 L_lw_59
L_ne_58:
    s_add_u32 m0, s96, 16384
    s_nop 0
    buffer_load_dwordx4 v9, s[40:43], s97 offen offset:0  lds
    buffer_load_dwordx4 v9, s[40:43], s97 offen offset:1024  lds
    buffer_load_dwordx4 v10, s[40:43], s97 offen offset:2048  lds
    buffer_load_dwordx4 v10, s[40:43], s97 offen offset:3072  lds
    s_cmp_lg_u32 s70, 0
    s_cbranch_scc1 L_no_62
    s_bitcmp1_b32 s78, s75
    s_cbranch_scc1 L_ns_60
    s_branch L_nf_63
L_nr_61:
    s_bitcmp1_b32 s78, s75
    s_cbranch_scc1 L_ns_60
    s_sub_u32 s80, s80, 1
    s_cbranch_scc1 L_ns_60
    s_sleep 2
L_nf_63:
    buffer_load_dword v18, v17, s[24:27], 0 offen sc1
    s_waitcnt vmcnt(0)
    v_cmp_eq_u32 s[78:79], s31, v18
    s_branch L_nr_61
L_ns_60:
    s_mov_b64 exec, 1
    ds_add_u32 v15, v16 offset:0
    s_mov_b64 exec, -1
    s_branch L_ne_64
L_no_62:
L_lw_65:
    ds_read_b32 v18, v15 offset:0
    s_waitcnt lgkmcnt(0)
    v_readfirstlane_b32 s58, v18
    s_cmp_lt_u32 s58, 2
    s_cbranch_scc1 L_lw_65
L_ne_64:
    s_add_u32 m0, s69, 16384
    s_nop 0
    buffer_load_dwordx4 v9, s[40:43], s68 offen offset:0  lds
    buffer_load_dwordx4 v9, s[40:43], s68 offen offset:1024  lds
    buffer_load_dwordx4 v10, s[40:43], s68 offen offset:2048  lds
    buffer_load_dwordx4 v10, s[40:43], s68 offen offset:3072  lds
L_kn_66:
    s_add_u32 s71, s71, 1
    s_add_u32 s58, s71, s62
    s_and_b32 s59, s71, 28
    s_lshr_b32 s59, s73, s59
    s_and_b32 s59, s59, 7
    s_and_b32 s58, s58, 3
    s_lshl2_add_u32 s58, s59, s58
    s_lshr_b32 s75, s58, 1
    s_cmp_eq_u32 s75, s74
    s_cbranch_scc1 L_kn_66
    s_mul_i32 s67, s58, 262144
    s_mul_i32 s68, s58, 131072
    s_add_u32 s69, s69, 32768
    s_cmp_ge_u32 s69, 98304
    s_cselect_b32 s58, 98304, 0
    s_sub_u32 s69, s69, s58
    s_waitcnt vmcnt(4)
    s_cmp_lg_u32 s70, 0
    s_cbranch_scc1 L_ns_67
    s_bitcmp1_b32 s78, s75
    s_cbranch_scc1 L_ns_67
    s_branch L_nf_70
L_nr_68:
    s_bitcmp1_b32 s78, s75
    s_cbranch_scc1 L_ns_67
    s_sub_u32 s80, s80, 1
    s_cbranch_scc1 L_ns_67
    s_sleep 2
L_nf_70:
    buffer_load_dword v18, v17, s[24:27], 0 offen sc1
    s_waitcnt vmcnt(0)
    v_cmp_eq_u32 s[78:79], s31, v18
    s_branch L_nr_68
L_ns_67:
    s_barrier
    s_mov_b32 m0, s69
    s_nop 0
    buffer_load_dwordx4 v5, s[36:39], s67 offen offset:0  lds
    buffer_load_dwordx4 v6, s[36:39], s67 offen offset:1024  lds
    buffer_load_dwordx4 v7, s[36:39], s67 offen offset:2048  lds
    buffer_load_dwordx4 v8, s[36:39], s67 offen offset:3072  lds
    s_add_u32 m0, s69, 16384
    s_nop 0
    buffer_load_dwordx4 v9, s[40:43], s68 offen offset:0  lds
    buffer_load_dwordx4 v9, s[40:43], s68 offen offset:1024  lds
    buffer_load_dwordx4 v10, s[40:43], s68 offen offset:2048  lds
    buffer_load_dwordx4 v10, s[40:43], s68 offen offset:3072  lds
L_kn_71:
    s_add_u32 s71, s71, 1
    s_add_u32 s58, s71, s62
    s_and_b32 s59, s71, 28
    s_lshr_b32 s59, s73, s59
    s_and_b32 s59, s59, 7
    s_and_b32 s58, s58, 3
    s_lshl2_add_u32 s58, s59, s58
    s_lshr_b32 s75, s58, 1
    s_cmp_eq_u32 s75, s74
    s_cbranch_scc1 L_kn_71
    s_mul_i32 s67, s58, 262144
    s_mul_i32 s68, s58, 131072
    s_add_u32 s69, s69, 32768
    s_cmp_ge_u32 s69, 98304
    s_cselect_b32 s58, 98304, 0
    s_sub_u32 s69, s69, s58
    s_waitcnt vmcnt(8)
    s_cmp_lg_u32 s70, 0
    s_cbranch_scc1 L_ns_72
    s_bitcmp1_b32 s78, s75
    s_cbranch_scc1 L_ns_72
    s_branch L_nf_75
L_nr_73:
    s_bitcmp1_b32 s78, s75
    s_cbranch_scc1 L_ns_72
    s_sub_u32 s80, s80, 1
    s_cbranch_scc1 L_ns_72
    s_sleep 2
L_nf_75:
    buffer_load_dword v18, v17, s[24:27], 0 offen sc1
    s_waitcnt vmcnt(0)
    v_cmp_eq_u32 s[78:79], s31, v18
    s_branch L_nr_73
L_ns_72:
    s_barrier
    buffer_load_dword v22, v21, s[24:27], 0 offen sc1
    s_mov_b32 m0, s69
    s_nop 0
    buffer_load_dwordx4 v5, s[36:39], s67 offen offset:0  lds
    buffer_load_dwordx4 v6, s[36:39], s67 offen offset:1024  lds
    buffer_load_dwordx4 v7, s[36:39], s67 offen offset:2048  lds
    buffer_load_dwordx4 v8, s[36:39], s67 offen offset:3072  lds
    s_add_u32 m0, s69, 16384
    s_nop 0
    buffer_load_dwordx4 v9, s[40:43], s68 offen offset:0  lds
    buffer_load_dwordx4 v9, s[40:43], s68 offen offset:1024  lds
    buffer_load_dwordx4 v10, s[40:43], s68 offen offset:2048  lds
    buffer_load_dwordx4 v10, s[40:43], s68 offen offset:3072  lds
L_kn_76:
    s_add_u32 s71, s71, 1
    s_add_u32 s58, s71, s62
    s_and_b32 s59, s71, 28
    s_lshr_b32 s59, s73, s59
    s_and_b32 s59, s59, 7
    s_and_b32 s58, s58, 3
    s_lshl2_add_u32 s58, s59, s58
    s_lshr_b32 s75, s58, 1
    s_cmp_eq_u32 s75, s74
    s_cbranch_scc1 L_kn_76
    s_mul_i32 s67, s58, 262144
    s_mul_i32 s68, s58, 131072
    s_add_u32 s69, s69, 32768
    s_cmp_ge_u32 s69, 98304
    s_cselect_b32 s58, 98304, 0
    s_sub_u32 s69, s69, s58
    s_waitcnt vmcnt(9)
    s_cmp_lg_u32 s70, 0
    s_cbranch_scc1 L_ns_77
    s_bitcmp1_b32 s78, s75
    s_cbranch_scc1 L_ns_77
    s_branch L_nf_80
L_nr_78:
    s_bitcmp1_b32 s78, s75
    s_cbranch_scc1 L_ns_77
    s_sub_u32 s80, s80, 1
    s_cbranch_scc1 L_ns_77
    s_sleep 2
L_nf_80:
    buffer_load_dword v18, v17, s[24:27], 0 offen sc1
    s_waitcnt vmcnt(0)
    v_cmp_eq_u32 s[78:79], s31, v18
    s_branch L_nr_78
L_ns_77:
    s_barrier
    s_mov_b32 m0, s69
    s_nop 0
    buffer_load_dwordx4 v5, s[36:39], s67 offen offset:0  lds
    buffer_load_dwordx4 v6, s[36:39], s67 offen offset:1024  lds
    buffer_load_dwordx4 v7, s[36:39], s67 offen offset:2048  lds
    buffer_load_dwordx4 v8, s[36:39], s67 offen offset:3072  lds
    s_add_u32 m0, s69, 16384
    s_nop 0
    buffer_load_dwordx4 v9, s[40:43], s68 offen offset:0  lds
    buffer_load_dwordx4 v9, s[40:43], s68 offen offset:1024  lds
    buffer_load_dwordx4 v10, s[40:43], s68 offen offset:2048  lds
    buffer_load_dwordx4 v10, s[40:43], s68 offen offset:3072  lds
L_kn_81:
    s_add_u32 s71, s71, 1
    s_add_u32 s58, s71, s62
    s_and_b32 s59, s71, 28
    s_lshr_b32 s59, s73, s59
    s_and_b32 s59, s59, 7
    s_and_b32 s58, s58, 3
    s_lshl2_add_u32 s58, s59, s58
    s_lshr_b32 s75, s58, 1
    s_cmp_eq_u32 s75, s74
    s_cbranch_scc1 L_kn_81
    s_mul_i32 s67, s58, 262144
    s_mul_i32 s68, s58, 131072
    s_add_u32 s69, s69, 32768
    s_cmp_ge_u32 s69, 98304
    s_cselect_b32 s58, 98304, 0
    s_sub_u32 s69, s69, s58
    s_waitcnt vmcnt(8)
    s_cmp_lg_u32 s70, 0
    s_cbranch_scc1 L_ns_82
    s_bitcmp1_b32 s78, s75
    s_cbranch_scc1 L_ns_82
    s_branch L_nf_85
L_nr_83:
    s_bitcmp1_b32 s78, s75
    s_cbranch_scc1 L_ns_82
    s_sub_u32 s80, s80, 1
    s_cbranch_scc1 L_ns_82
    s_sleep 2
L_nf_85:
    buffer_load_dword v18, v17, s[24:27], 0 offen sc1
    s_waitcnt vmcnt(0)
    v_cmp_eq_u32 s[78:79], s31, v18
    s_branch L_nr_83
L_ns_82:
    s_barrier
    v_cmp_ne_u32 vcc, s31, v22
    s_cmp_eq_u64 vcc, 0
    s_cbranch_scc1 L_sp_86
    s_mov_b32 s66, 131072
    s_branch L_poll_87x
L_poll_87:
    s_sleep 4
L_poll_87x:
    buffer_load_dword v22, v21, s[24:27], 0 offen sc1
L_pollw_88:
    s_waitcnt vmcnt(0)
    v_cmp_ne_u32 vcc, s31, v22
    s_sub_u32 s66, s66, 1
    s_cbranch_scc1 L_polld_89
    s_cmp_lg_u64 vcc, 0
    s_cbranch_scc1 L_poll_87
L_polld_89:
L_sp_86:
    buffer_load_dword v22, v20, s[48:51], 0 offen sc1
    s_mov_b32 m0, s69
    s_nop 0
    buffer_load_dwordx4 v5, s[36:39], s67 offen offset:0  lds
    buffer_load_dwordx4 v6, s[36:39], s67 offen offset:1024  lds
    buffer_load_dwordx4 v7, s[36:39], s67 offen offset:2048  lds
    buffer_load_dwordx4 v8, s[36:39], s67 offen offset:3072  lds
    s_add_u32 m0, s69, 16384
    s_nop 0
    buffer_load_dwordx4 v9, s[40:43], s68 offen offset:0  lds
    buffer_load_dwordx4 v9, s[40:43], s68 offen offset:1024  lds
    buffer_load_dwordx4 v10, s[40:43], s68 offen offset:2048  lds
    buffer_load_dwordx4 v10, s[40:43], s68 offen offset:3072  lds
L_kn_90:
    s_add_u32 s71, s71, 1
    s_add_u32 s58, s71, s62
    s_and_b32 s59, s71, 28
    s_lshr_b32 s59, s73, s59
    s_and_b32 s59, s59, 7
    s_and_b32 s58, s58, 3
    s_lshl2_add_u32 s58, s59, s58
    s_lshr_b32 s75, s58, 1
    s_cmp_eq_u32 s75, s74
    s_cbranch_scc1 L_kn_90
    s_mul_i32 s67, s58, 262144
    s_mul_i32 s68, s58, 131072
    s_add_u32 s69, s69, 32768
    s_cmp_ge_u32 s69, 98304
    s_cselect_b32 s58, 98304, 0
    s_sub_u32 s69, s69, s58
    s_waitcnt vmcnt(9)
    s_cmp_lg_u32 s70, 0
    s_cbranch_scc1 L_ns_91
    s_cmp_eq_u64 s[78:79], -1
    s_cbranch_scc1 L_ns_91
    s_branch L_nf_94
L_nr_92:
    s_cmp_eq_u64 s[78:79], -1
    s_cbranch_scc1 L_ns_91
    s_sub_u32 s80, s80, 1
    s_cbranch_scc1 L_ns_91
    s_sleep 2
L_nf_94:
    buffer_load_dword v18, v17, s[24:27], 0 offen sc1
    s_waitcnt vmcnt(0)
    v_cmp_eq_u32 s[78:79], s31, v18
    s_branch L_nr_92
L_ns_91:
    s_barrier
    s_mov_b32 m0, s69
    s_nop 0
    buffer_load_dwordx4 v5, s[36:39], s67 offen offset:0  lds
    buffer_load_dwordx4 v6, s[36:39], s67 offen offset:1024  lds
    buffer_load_dwordx4 v7, s[36:39], s67 offen offset:2048  lds
    buffer_load_dwordx4 v8, s[36:39], s67 offen offset:3072  lds
    s_add_u32 m0, s69, 16384
    s_nop 0
    buffer_load_dwordx4 v9, s[40:43], s68 offen offset:0  lds
    buffer_load_dwordx4 v9, s[40:43], s68 offen offset:1024  lds
    buffer_load_dwordx4 v10, s[40:43], s68 offen offset:2048  lds
    buffer_load_dwordx4 v10, s[40:43], s68 offen offset:3072  lds
L_kn_95:
    s_add_u32 s71, s71, 1
    s_add_u32 s58, s71, s62
    s_and_b32 s59, s71, 28
    s_lshr_b32 s59, s73, s59
    s_and_b32 s59, s59, 7
    s_and_b32 s58, s58, 3
    s_lshl2_add_u32 s58, s59, s58
    s_lshr_b32 s75, s58, 1
    s_cmp_eq_u32 s75, s74
    s_cbranch_scc1 L_kn_95
    s_mul_i32 s67, s58, 262144
    s_mul_i32 s68, s58, 131072
    s_add_u32 s69, s69, 32768
    s_cmp_ge_u32 s69, 98304
    s_cselect_b32 s58, 98304, 0
    s_sub_u32 s69, s69, s58
    s_waitcnt vmcnt(8)
    s_barrier
    s_mov_b32 m0, s69
    s_nop 0
    buffer_load_dwordx4 v5, s[36:39], s67 offen offset:0  lds
    buffer_load_dwordx4 v6, s[36:39], s67 offen offset:1024  lds
    buffer_load_dwordx4 v7, s[36:39], s67 offen offset:2048  lds
    buffer_load_dwordx4 v8, s[36:39], s67 offen offset:3072  lds
    s_add_u32 m0, s69, 16384
    s_nop 0
    buffer_load_dwordx4 v9, s[40:43], s68 offen offset:0  lds
    buffer_load_dwordx4 v9, s[40:43], s68 offen offset:1024  lds
    buffer_load_dwordx4 v10, s[40:43], s68 offen offset:2048  lds
    buffer_load_dwordx4 v10, s[40:43], s68 offen offset:3072  lds
L_kn_96:
    s_add_u32 s71, s71, 1
    s_add_u32 s58, s71, s62
    s_and_b32 s59, s71, 28
    s_lshr_b32 s59, s73, s59
    s_and_b32 s59, s59, 7
    s_and_b32 s58, s58, 3
    s_lshl2_add_u32 s58, s59, s58
    s_lshr_b32 s75, s58, 1
    s_cmp_eq_u32 s75, s74
    s_cbranch_scc1 L_kn_96
    s_mul_i32 s67, s58, 262144
    s_mul_i32 s68, s58, 131072
    s_add_u32 s69, s69, 32768
    s_cmp_ge_u32 s69, 98304
    s_cselect_b32 s58, 98304, 0
    s_sub_u32 s69, s69, s58
    v_lshlrev_b32 v40, 16, v22
    v_and_b32 v42, 0xffff0000, v22
    v_mul_f32 v40, 0x35000000, v40
    v_mul_f32 v42, 0x35000000, v42
    v_xor_b32 v41, 0x80000000, v40
    v_xor_b32 v43, 0x80000000, v42
    v_pk_add_f32 v[144:145], v[144:145], v[40:41]
    v_pk_add_f32 v[160:161], v[160:161], v[42:43]
    v_pk_add_f32 v[146:147], v[146:147], v[40:41]
    v_pk_add_f32 v[162:163], v[162:163], v[42:43]
    v_pk_add_f32 v[148:149], v[148:149], v[40:41]
    v_pk_add_f32 v[164:165], v[164:165], v[42:43]
    v_pk_add_f32 v[150:151], v[150:151], v[40:41]
    v_pk_add_f32 v[166:167], v[166:167], v[42:43]
    v_pk_add_f32 v[152:153], v[152:153], v[40:41]
    v_pk_add_f32 v[168:169], v[168:169], v[42:43]
    v_pk_add_f32 v[154:155], v[154:155], v[40:41]
    v_pk_add_f32 v[170:171], v[170:171], v[42:43]
    v_pk_add_f32 v[156:157], v[156:157], v[40:41]
    v_pk_add_f32 v[172:173], v[172:173], v[42:43]
    v_pk_add_f32 v[158:159], v[158:159], v[40:41]
    v_pk_add_f32 v[174:175], v[174:175], v[42:43]
    s_lshl_b32 s99, s70, 12
    s_add_u32 s99, s99, 98304
    v_add_u32 v12, s99, v11
    v_lshl_add_u32 v13, v1, 4, s99
    v_lshlrev_b32 v11, 4, v1
    v_cvt_pk_bf16_f32 v40, v144, v145
    v_cvt_pk_bf16_f32 v41, v146, v147
    v_cvt_pk_bf16_f32 v42, v148, v149
    v_cvt_pk_bf16_f32 v43, v150, v151
    v_cvt_pk_bf16_f32 v44, v152, v153
    v_cvt_pk_bf16_f32 v45, v154, v155
    v_cvt_pk_bf16_f32 v46, v156, v157
    v_cvt_pk_bf16_f32 v47, v158, v159
    v_permlane32_swap_b32 v40, v42
    v_permlane32_swap_b32 v41, v43
    ds_write_b128 v12, v[40:43] offset:0
    v_permlane32_swap_b32 v44, v46
    v_permlane32_swap_b32 v45, v47
    ds_write_b128 v12, v[44:47] offset:32
    v_cvt_pk_bf16_f32 v48, v160, v161
    v_cvt_pk_bf16_f32 v49, v162, v163
    v_cvt_pk_bf16_f32 v50, v164, v165
    v_cvt_pk_bf16_f32 v51, v166, v167
    v_cvt_pk_bf16_f32 v52, v168, v169
    v_cvt_pk_bf16_f32 v53, v170, v171
    v_cvt_pk_bf16_f32 v54, v172, v173
    v_cvt_pk_bf16_f32 v55, v174, v175
    v_permlane32_swap_b32 v48, v50
    v_permlane32_swap_b32 v49, v51
    ds_write_b128 v12, v[48:51] offset:2048
    v_permlane32_swap_b32 v52, v54
    v_permlane32_swap_b32 v53, v55
    ds_write_b128 v12, v[52:55] offset:2080
    s_waitcnt lgkmcnt(0)
    ds_read_b128 v[24:27], v13 offset:0
    ds_read_b128 v[28:31], v13 offset:1024
    ds_read_b128 v[32:35], v13 offset:2048
    ds_read_b128 v[36:39], v13 offset:3072
    s_waitcnt lgkmcnt(0)
    s_waitcnt vmcnt(8)
    s_barrier
    buffer_store_dwordx4 v[24:27], v11, s[52:55], s81 offen offset:0 sc1
    buffer_store_dwordx4 v[28:31], v11, s[52:55], s81 offen offset:1024 sc1
    buffer_store_dwordx4 v[32:35], v11, s[52:55], s82 offen offset:0 sc1
    buffer_store_dwordx4 v[36:39], v11, s[52:55], s82 offen offset:1024 sc1
    s_mov_b32 m0, s69
    s_nop 0
    buffer_load_dwordx4 v5, s[36:39], s67 offen offset:0  lds
    buffer_load_dwordx4 v6, s[36:39], s67 offen offset:1024  lds
    buffer_load_dwordx4 v7, s[36:39], s67 offen offset:2048  lds
    buffer_load_dwordx4 v8, s[36:39], s67 offen offset:3072  lds
    s_add_u32 m0, s69, 16384
    s_nop 0
    buffer_load_dwordx4 v9, s[40:43], s68 offen offset:0  lds
    buffer_load_dwordx4 v9, s[40:43], s68 offen offset:1024  lds
    buffer_load_dwordx4 v10, s[40:43], s68 offen offset:2048  lds
    buffer_load_dwordx4 v10, s[40:43], s68 offen offset:3072  lds
L_kn_97:
    s_add_u32 s71, s71, 1
    s_add_u32 s58, s71, s62
    s_and_b32 s59, s71, 28
    s_lshr_b32 s59, s73, s59
    s_and_b32 s59, s59, 7
    s_and_b32 s58, s58, 3
    s_lshl2_add_u32 s58, s59, s58
    s_lshr_b32 s75, s58, 1
    s_cmp_eq_u32 s75, s74
    s_cbranch_scc1 L_kn_97
    s_mul_i32 s67, s58, 262144
    s_mul_i32 s68, s58, 131072
    s_add_u32 s69, s69, 32768
    s_cmp_ge_u32 s69, 98304
    s_cselect_b32 s58, 98304, 0
    s_sub_u32 s69, s69, s58
    s_waitcnt vmcnt(12)
    s_barrier
    s_mov_b32 m0, s69
    s_nop 0
    buffer_load_dwordx4 v5, s[36:39], s67 offen offset:0  lds
    buffer_load_dwordx4 v6, s[36:39], s67 offen offset:1024  lds
    buffer_load_dwordx4 v7, s[36:39], s67 offen offset:2048  lds
    buffer_load_dwordx4 v8, s[36:39], s67 offen offset:3072  lds
    s_add_u32 m0, s69, 16384
    s_nop 0
    buffer_load_dwordx4 v9, s[40:43], s68 offen offset:0  lds
    buffer_load_dwordx4 v9, s[40:43], s68 offen offset:1024  lds
    buffer_load_dwordx4 v10, s[40:43], s68 offen offset:2048  lds
    buffer_load_dwordx4 v10, s[40:43], s68 offen offset:3072  lds
L_kn_98:
    s_add_u32 s71, s71, 1
    s_add_u32 s58, s71, s62
    s_and_b32 s59, s71, 28
    s_lshr_b32 s59, s73, s59
    s_and_b32 s59, s59, 7
    s_and_b32 s58, s58, 3
    s_lshl2_add_u32 s58, s59, s58
    s_lshr_b32 s75, s58, 1
    s_cmp_eq_u32 s75, s74
    s_cbranch_scc1 L_kn_98
    s_mul_i32 s67, s58, 262144
    s_mul_i32 s68, s58, 131072
    s_add_u32 s69, s69, 32768
    s_cmp_ge_u32 s69, 98304
    s_cselect_b32 s58, 98304, 0
    s_sub_u32 s69, s69, s58
    s_waitcnt vmcnt(8)
    s_barrier
    s_mov_b64 exec, 1
    buffer_store_dword v19, v2, s[24:27], 0 offen sc1
    s_mov_b64 exec, -1
    s_mov_b32 m0, s69
    s_nop 0
    buffer_load_dwordx4 v5, s[36:39], s67 offen offset:0  lds
    buffer_load_dwordx4 v6, s[36:39], s67 offen offset:1024  lds
    buffer_load_dwordx4 v7, s[36:39], s67 offen offset:2048  lds
    buffer_load_dwordx4 v8, s[36:39], s67 offen offset:3072  lds
    s_add_u32 m0, s69, 16384
    s_nop 0
    buffer_load_dwordx4 v9, s[40:43], s68 offen offset:0  lds
    buffer_load_dwordx4 v9, s[40:43], s68 offen offset:1024  lds
    buffer_load_dwordx4 v10, s[40:43], s68 offen offset:2048  lds
    buffer_load_dwordx4 v10, s[40:43], s68 offen offset:3072  lds
L_kn_99:
    s_add_u32 s71, s71, 1
    s_add_u32 s58, s71, s62
    s_and_b32 s59, s71, 28
    s_lshr_b32 s59, s73, s59
    s_and_b32 s59, s59, 7
    s_and_b32 s58, s58, 3
    s_lshl2_add_u32 s58, s59, s58
    s_lshr_b32 s75, s58, 1
    s_cmp_eq_u32 s75, s74
    s_cbranch_scc1 L_kn_99
    s_mul_i32 s67, s58, 262144
    s_mul_i32 s68, s58, 131072
    s_add_u32 s69, s69, 32768
    s_cmp_ge_u32 s69, 98304
    s_cselect_b32 s58, 98304, 0
    s_sub_u32 s69, s69, s58
    s_mov_b32 s66, 13
L_lloop_100:
    s_waitcnt vmcnt(8)
    s_barrier
    s_mov_b32 m0, s69
    s_nop 0
    buffer_load_dwordx4 v5, s[36:39], s67 offen offset:0  lds
    buffer_load_dwordx4 v6, s[36:39], s67 offen offset:1024  lds
    buffer_load_dwordx4 v7, s[36:39], s67 offen offset:2048  lds
    buffer_load_dwordx4 v8, s[36:39], s67 offen offset:3072  lds
    s_add_u32 m0, s69, 16384
    s_nop 0
    buffer_load_dwordx4 v9, s[40:43], s68 offen offset:0  lds
    buffer_load_dwordx4 v9, s[40:43], s68 offen offset:1024  lds
    buffer_load_dwordx4 v10, s[40:43], s68 offen offset:2048  lds
    buffer_load_dwordx4 v10, s[40:43], s68 offen offset:3072  lds
L_kn_101:
    s_add_u32 s71, s71, 1
    s_add_u32 s58, s71, s62
    s_and_b32 s59, s71, 28
    s_lshr_b32 s59, s73, s59
    s_and_b32 s59, s59, 7
    s_and_b32 s58, s58, 3
    s_lshl2_add_u32 s58, s59, s58
    s_lshr_b32 s75, s58, 1
    s_cmp_eq_u32 s75, s74
    s_cbranch_scc1 L_kn_101
    s_mul_i32 s67, s58, 262144
    s_mul_i32 s68, s58, 131072
    s_add_u32 s69, s69, 32768
    s_cmp_ge_u32 s69, 98304
    s_cselect_b32 s58, 98304, 0
    s_sub_u32 s69, s69, s58
    s_sub_u32 s66, s66, 1
    s_cmp_lg_u32 s66, 0
    s_cbranch_scc1 L_lloop_100
    s_lshr_b32 s58, s56, 8
    s_and_b32 s58, s58, 7
    s_lshl_b32 s58, s58, 1
    s_lshl_b32 s83, s63, 4
    s_add_u32 s58, s58, s83
    s_lshl_b32 s58, s58, 7
    s_add_u32 s58, s58, 139264
    v_lshl_add_u32 v14, v1, 2, s58
    v_lshrrev_b32 v2, 4, v1
    v_and_b32 v3, 15, v1
    v_xor_b32 v3, v3, v2
    v_lshlrev_b32 v3, 4, v3
    v_lshl_add_u32 v3, v2, 11, v3
    s_lshl_b32 s83, s56, 10
    s_lshr_b32 s58, s57, 3
    s_add_u32 s83, s83, s58
    s_lshl_b32 s58, s63, 16
    s_add_u32 s83, s83, s58
    s_lshr_b32 s58, s70, 1
    s_lshl_b32 s58, s58, 17
    s_add_u32 s83, s83, s58
    s_and_b32 s58, s70, 1
    s_lshl_b32 s58, s58, 15
    s_add_u32 s83, s83, s58
    v_xor_b32 v28, 0, v3
    v_xor_b32 v29, 64, v3
    s_add_u32 s84, s83, 7168
    v_xor_b32 v30, 128, v3
    s_add_u32 s85, s83, 14336
    v_xor_b32 v31, 192, v3
    s_add_u32 s86, s83, 21504
    s_waitcnt vmcnt(8)
    s_barrier
    v_mov_b32 v24, s31
    s_cmp_lg_u32 s70, 0
    s_cbranch_scc1 L_np_102
    buffer_load_dword v24, v14, s[24:27], 0 offen sc1
L_np_102:
    s_mov_b32 m0, s69
    s_nop 0
    buffer_load_dwordx4 v5, s[36:39], s67 offen offset:0  lds
    buffer_load_dwordx4 v6, s[36:39], s67 offen offset:1024  lds
    buffer_load_dwordx4 v7, s[36:39], s67 offen offset:2048  lds
    buffer_load_dwordx4 v8, s[36:39], s67 offen offset:3072  lds
    s_add_u32 m0, s69, 16384
    s_nop 0
    buffer_load_dwordx4 v9, s[40:43], s68 offen offset:0  lds
    buffer_load_dwordx4 v9, s[40:43], s68 offen offset:1024  lds
    buffer_load_dwordx4 v10, s[40:43], s68 offen offset:2048  lds
    buffer_load_dwordx4 v10, s[40:43], s68 offen offset:3072  lds
L_kn_103:
    s_add_u32 s71, s71, 1
    s_add_u32 s58, s71, s62
    s_and_b32 s59, s71, 28
    s_lshr_b32 s59, s73, s59
    s_and_b32 s59, s59, 7
    s_and_b32 s58, s58, 3
    s_lshl2_add_u32 s58, s59, s58
    s_lshr_b32 s75, s58, 1
    s_cmp_eq_u32 s75, s74
    s_cbranch_scc1 L_kn_103
    s_mul_i32 s67, s58, 262144
    s_mul_i32 s68, s58, 131072
    s_add_u32 s69, s69, 32768
    s_cmp_ge_u32 s69, 98304
    s_cselect_b32 s58, 98304, 0
    s_sub_u32 s69, s69, s58
    s_waitcnt vmcnt(8)
    v_cmp_ne_u32 vcc, s31, v24
    s_cmp_eq_u64 vcc, 0
    s_cbranch_scc1 L_np_104
    s_mov_b32 s66, 131072
    s_branch L_poll_105x
L_poll_105:
    s_sleep 4
L_poll_105x:
    buffer_load_dword v24, v14, s[24:27], 0 offen sc1
L_pollw_106:
    s_waitcnt vmcnt(0)
    v_cmp_ne_u32 vcc, s31, v24
    s_sub_u32 s66, s66, 1
    s_cbranch_scc1 L_polld_107
    s_cmp_lg_u64 vcc, 0
    s_cbranch_scc1 L_poll_105
L_polld_107:
L_np_104:
    s_barrier
    s_mov_b32 m0, s69
    s_nop 0
    buffer_load_dwordx4 v5, s[36:39], s67 offen offset:0  lds
    buffer_load_dwordx4 v6, s[36:39], s67 offen offset:1024  lds
    buffer_load_dwordx4 v7, s[36:39], s67 offen offset:2048  lds
    buffer_load_dwordx4 v8, s[36:39], s67 offen offset:3072  lds
    s_add_u32 m0, s69, 16384
    s_nop 0
    buffer_load_dwordx4 v9, s[40:43], s68 offen offset:0  lds
    buffer_load_dwordx4 v9, s[40:43], s68 offen offset:1024  lds
    buffer_load_dwordx4 v10, s[40:43], s68 offen offset:2048  lds
    buffer_load_dwordx4 v10, s[40:43], s68 offen offset:3072  lds
L_kn_108:
    s_add_u32 s71, s71, 1
    s_add_u32 s58, s71, s62
    s_and_b32 s59, s71, 28
    s_lshr_b32 s59, s73, s59
    s_and_b32 s59, s59, 7
    s_and_b32 s58, s58, 3
    s_lshl2_add_u32 s58, s59, s58
    s_lshr_b32 s75, s58, 1
    s_cmp_eq_u32 s75, s74
    s_cbranch_scc1 L_kn_108
    s_mul_i32 s67, s58, 262144
    s_mul_i32 s68, s58, 131072
    s_add_u32 s69, s69, 32768
    s_cmp_ge_u32 s69, 98304
    s_cselect_b32 s58, 98304, 0
    s_sub_u32 s69, s69, s58
    s_lshl_b32 s58, s70, 12
    s_add_u32 m0, s58, 98304
    s_nop 0
    buffer_load_dwordx4 v28, s[52:55], s83 offen offset:0 sc1 lds
    buffer_load_dwordx4 v29, s[52:55], s84 offen offset:1024 sc1 lds
    buffer_load_dwordx4 v30, s[52:55], s85 offen offset:2048 sc1 lds
    buffer_load_dwordx4 v31, s[52:55], s86 offen offset:3072 sc1 lds
    s_waitcnt vmcnt(12)
    s_barrier
    s_waitcnt vmcnt(4)
    s_barrier
    s_waitcnt vmcnt(0)
    s_barrier
    s_endpgm
L_comp_3:
    s_and_b32 s60, s28, 1
    s_bfe_u32 s61, s28, 0x10001
    v_bfe_u32 v2, v1, 2, 2
    v_lshrrev_b32 v3, 5, v1
    v_lshl_add_u32 v3, v3, 3, v2
    v_lshlrev_b32 v104, 8, v3
    v_bfe_u32 v3, v1, 4, 1
    v_bfe_u32 v4, v1, 1, 1
    v_lshl_add_u32 v3, v3, 1, v4
    s_lshl_b32 s58, s60, 3
    v_add_u32 v3, s58, v3
    v_lshlrev_b32 v2, 2, v2
    v_xor_b32 v3, v3, v2
    v_and_b32 v4, 1, v1
    v_lshlrev_b32 v4, 3, v4
    v_add_u32 v104, v104, v4
    v_xor_b32 v2, 4, v3
    v_lshl_add_u32 v105, v2, 4, v104
    v_lshl_add_u32 v104, v3, 4, v104
    v_lshrrev_b32 v3, 5, v1
    v_lshlrev_b32 v3, 11, v3
    v_and_b32 v2, 31, v1
    v_lshl_add_u32 v3, v2, 4, v3
    s_lshl_b32 s58, s61, 10
    s_add_u32 s58, s58, 16384
    v_add_u32 v106, s58, v3
    s_mov_b32 s67, 0
    v_add_u32 v107, s67, v104
    v_add_u32 v108, s67, v105
    v_add_u32 v109, s67, v106
    s_mov_b32 s72, 0xbdd2d3e8
    s_mov_b32 s73, 0xbdd2d3e8
    s_mov_b32 s74, 1.0
    s_mov_b32 s75, 1.0
    v_mov_b32 v126, 0xc0135761
    v_mov_b32 v127, 0xc0135761
    v_lshrrev_b32 v2, 5, v1
    v_lshlrev_b32 v123, 14, v2
    v_lshlrev_b32 v124, 11, v2
    v_and_b32 v2, 31, v1
    v_lshl_add_u32 v123, v2, 4, v123
    v_lshl_add_u32 v124, v2, 4, v124
    s_lshl_b32 s58, s56, 10
    s_lshl_b32 s76, s60, 17
    s_add_u32 s58, s58, s76
    s_lshl_b32 s76, s61, 10
    s_add_u32 s58, s58, s76
    s_add_u32 s58, s58, s57
    v_add_u32 v123, s58, v123
    s_cmp_eq_u32 s60, 0
    s_mov_b32 s58, 16384
    s_cselect_b32 s58, 81920, s58
    s_add_u32 s58, s58, s76
    v_add_u32 v124, s58, v124
    s_add_u32 s48, s18, 0x1800000
    s_addc_u32 s49, s19, 0
    s_mov_b32 s50, 0x700000
    s_mov_b32 s51, 0x00020000
    s_lshr_b32 s58, s56, 8
    s_cmp_ge_u32 s58, 14
    s_cselect_b32 s59, 2, 0
    s_add_u32 s58, s58, s59
    s_lshl_b32 s58, s58, 7
    s_lshl_b32 s59, s57, 1
    s_add_u32 s58, s58, s59
    s_add_u32 s58, s58, 147456
    v_mov_b32 v110, s58
    v_mov_b32 v111, 141312
    s_and_b32 s58, s29, 1
    s_lshl_b32 s58, s58, 2
    s_and_b32 s57, s30, 3
    s_add_u32 s57, s57, s58
    s_lshl_b32 s57, s57, 11
    s_bfe_u32 s63, s2, 0x10002
    s_bfe_u32 s58, s2, 0x10001
    s_lshl_b32 s58, s58, 3
    s_lshr_b32 s56, s30, 2
    s_add_u32 s56, s56, s58
    s_lshl_b32 s56, s56, 8
    s_mov_b32 s36, s20
    s_mov_b32 s37, s21
    s_mov_b32 s38, 0x400000
    s_mov_b32 s39, 0x00020000
    s_add_u32 s40, s18, 0x3000000
    s_addc_u32 s41, s19, 0
    s_mov_b32 s42, 0x800000
    s_mov_b32 s43, 0x00020000
    v_and_b32 v2, 31, v1
    v_lshlrev_b32 v112, 11, v2
    v_lshrrev_b32 v2, 5, v1
    v_lshl_add_u32 v112, v2, 4, v112
    s_lshl_b32 s58, s56, 10
    v_add_u32 v112, s58, v112
    s_lshl_b32 s58, s60, 17
    v_add_u32 v112, s58, v112
    s_lshr_b32 s58, s57, 3
    v_add_u32 v112, s58, v112
    s_mul_i32 s58, s61, 128
    v_add_u32 v112, s58, v112
    v_and_b32 v2, 31, v1
    s_lshl_b32 s58, s60, 13
    s_add_u32 s58, s58, 98304
    v_lshl_add_u32 v3, v2, 8, s58
    v_lshrrev_b32 v4, 5, v1
    v_lshl_add_u32 v3, v4, 3, v3
    v_and_b32 v2, 15, v1
    s_lshl_b32 s58, s61, 3
    v_xor_b32 v2, s58, v2
    v_lshl_add_u32 v3, v2, 4, v3
    v_xor_b32 v115, 0, v3
    v_xor_b32 v116, 16, v3
    v_xor_b32 v117, 32, v3
    v_xor_b32 v118, 48, v3
    v_xor_b32 v119, 64, v3
    v_xor_b32 v120, 80, v3
    v_xor_b32 v121, 96, v3
    v_xor_b32 v122, 112, v3
    s_lshl_b32 s59, s63, 16
    v_lshlrev_b32 v113, 4, v1
    s_lshl_b32 s69, s2, 2
    s_add_u32 s69, s69, s28
    s_lshl_b32 s58, s69, 7
    v_mov_b32 v114, s58
    s_lshl_b32 s69, s69, 13
    s_add_u32 s70, s69, 4096
    v_mov_b32 v3, 1
    v_lshlrev_b32 v8, 16, v160
    v_and_b32 v9, 0xffff0000, v160
    v_lshlrev_b32 v10, 16, v161
    v_and_b32 v11, 0xffff0000, v161
    v_lshlrev_b32 v24, 16, v160
    v_and_b32 v25, 0xffff0000, v160
    v_lshlrev_b32 v26, 16, v161
    v_and_b32 v27, 0xffff0000, v161
    v_lshlrev_b32 v12, 16, v162
    v_and_b32 v13, 0xffff0000, v162
    v_lshlrev_b32 v14, 16, v163
    v_and_b32 v15, 0xffff0000, v163
    v_lshlrev_b32 v28, 16, v162
    v_and_b32 v29, 0xffff0000, v162
    v_lshlrev_b32 v30, 16, v163
    v_and_b32 v31, 0xffff0000, v163
    v_lshlrev_b32 v16, 16, v164
    v_and_b32 v17, 0xffff0000, v164
    v_lshlrev_b32 v18, 16, v165
    v_and_b32 v19, 0xffff0000, v165
    v_lshlrev_b32 v32, 16, v164
    v_and_b32 v33, 0xffff0000, v164
    v_lshlrev_b32 v34, 16, v165
    v_and_b32 v35, 0xffff0000, v165
    v_lshlrev_b32 v20, 16, v166
    v_and_b32 v21, 0xffff0000, v166
    v_lshlrev_b32 v22, 16, v167
    v_and_b32 v23, 0xffff0000, v167
    v_lshlrev_b32 v36, 16, v166
    v_and_b32 v37, 0xffff0000, v166
    v_lshlrev_b32 v38, 16, v167
    v_and_b32 v39, 0xffff0000, v167
    v_lshlrev_b32 v40, 16, v168
    v_and_b32 v41, 0xffff0000, v168
    v_lshlrev_b32 v42, 16, v169
    v_and_b32 v43, 0xffff0000, v169
    v_lshlrev_b32 v56, 16, v168
    v_and_b32 v57, 0xffff0000, v168
    v_lshlrev_b32 v58, 16, v169
    v_and_b32 v59, 0xffff0000, v169
    v_lshlrev_b32 v44, 16, v170
    v_and_b32 v45, 0xffff0000, v170
    v_lshlrev_b32 v46, 16, v171
    v_and_b32 v47, 0xffff0000, v171
    v_lshlrev_b32 v60, 16, v170
    v_and_b32 v61, 0xffff0000, v170
    v_lshlrev_b32 v62, 16, v171
    v_and_b32 v63, 0xffff0000, v171
    v_lshlrev_b32 v48, 16, v172
    v_and_b32 v49, 0xffff0000, v172
    v_lshlrev_b32 v50, 16, v173
    v_and_b32 v51, 0xffff0000, v173
    v_lshlrev_b32 v64, 16, v172
    v_and_b32 v65, 0xffff0000, v172
    v_lshlrev_b32 v66, 16, v173
    v_and_b32 v67, 0xffff0000, v173
    v_lshlrev_b32 v52, 16, v174
    v_and_b32 v53, 0xffff0000, v174
    v_lshlrev_b32 v54, 16, v175
    v_and_b32 v55, 0xffff0000, v175
    v_lshlrev_b32 v68, 16, v174
    v_and_b32 v69, 0xffff0000, v174
    v_lshlrev_b32 v70, 16, v175
    v_and_b32 v71, 0xffff0000, v175
    s_barrier
    ds_read_b64_tr_b16 v[72:73], v107 offset:0
    ds_read_b64_tr_b16 v[74:75], v107 offset:1024
    ds_read_b128 v[88:91], v109 offset:0
    ds_read_b128 v[92:95], v109 offset:512
    ds_read_b64_tr_b16 v[76:77], v108 offset:0
    ds_read_b64_tr_b16 v[78:79], v108 offset:1024
    s_mov_b32 s68, 32
.p2align 6
L_cloop_109:
    s_waitcnt lgkmcnt(3)
    v_mfma_f32_32x32x16_bf16 v[8:23], v[72:75], v[88:91], v[8:23]
    ds_read_b64_tr_b16 v[80:81], v107 offset:4096
    ds_read_b64_tr_b16 v[82:83], v107 offset:5120
    ds_read_b128 v[96:99], v109 offset:4096
    s_waitcnt lgkmcnt(5)
    v_mfma_f32_32x32x16_bf16 v[24:39], v[72:75], v[92:95], v[24:39]
    ds_read_b128 v[100:103], v109 offset:4608
    ds_read_b64_tr_b16 v[84:85], v108 offset:4096
    ds_read_b64_tr_b16 v[86:87], v108 offset:5120
    s_waitcnt lgkmcnt(6)
    v_mfma_f32_32x32x16_bf16 v[56:71], v[76:79], v[92:95], v[56:71]
    v_mfma_f32_32x32x16_bf16 v[40:55], v[76:79], v[88:91], v[40:55]
    s_waitcnt lgkmcnt(3)
    v_mfma_f32_32x32x16_bf16 v[8:23], v[80:83], v[96:99], v[8:23]
    ds_read_b64_tr_b16 v[72:73], v107 offset:8192
    ds_read_b64_tr_b16 v[74:75], v107 offset:9216
    ds_read_b128 v[88:91], v109 offset:8192
    s_waitcnt lgkmcnt(5)
    v_mfma_f32_32x32x16_bf16 v[24:39], v[80:83], v[100:103], v[24:39]
    ds_read_b128 v[92:95], v109 offset:8704
    ds_read_b64_tr_b16 v[76:77], v108 offset:8192
    ds_read_b64_tr_b16 v[78:79], v108 offset:9216
    s_waitcnt lgkmcnt(6)
    v_mfma_f32_32x32x16_bf16 v[56:71], v[84:87], v[100:103], v[56:71]
    v_mfma_f32_32x32x16_bf16 v[40:55], v[84:87], v[96:99], v[40:55]
    s_waitcnt lgkmcnt(3)
    v_mfma_f32_32x32x16_bf16 v[8:23], v[72:75], v[88:91], v[8:23]
    ds_read_b64_tr_b16 v[80:81], v107 offset:12288
    ds_read_b64_tr_b16 v[82:83], v107 offset:13312
    ds_read_b128 v[96:99], v109 offset:12288
    s_waitcnt lgkmcnt(5)
    v_mfma_f32_32x32x16_bf16 v[24:39], v[72:75], v[92:95], v[24:39]
    ds_read_b128 v[100:103], v109 offset:12800
    ds_read_b64_tr_b16 v[84:85], v108 offset:12288
    ds_read_b64_tr_b16 v[86:87], v108 offset:13312
    s_waitcnt lgkmcnt(6)
    v_mfma_f32_32x32x16_bf16 v[56:71], v[76:79], v[92:95], v[56:71]
    v_mfma_f32_32x32x16_bf16 v[40:55], v[76:79], v[88:91], v[40:55]
    s_add_u32 s67, s67, 32768
    s_cmp_ge_u32 s67, 98304
    s_cselect_b32 s67, 0, s67
    v_add_u32 v107, s67, v104
    v_add_u32 v108, s67, v105
    v_add_u32 v109, s67, v106
    s_waitcnt lgkmcnt(0)
    s_barrier
    v_mfma_f32_32x32x16_bf16 v[8:23], v[80:83], v[96:99], v[8:23]
    ds_read_b64_tr_b16 v[72:73], v107 offset:0
    ds_read_b64_tr_b16 v[74:75], v107 offset:1024
    ds_read_b128 v[88:91], v109 offset:0
    v_mfma_f32_32x32x16_bf16 v[24:39], v[80:83], v[100:103], v[24:39]
    ds_read_b128 v[92:95], v109 offset:512
    ds_read_b64_tr_b16 v[76:77], v108 offset:0
    ds_read_b64_tr_b16 v[78:79], v108 offset:1024
    v_mfma_f32_32x32x16_bf16 v[56:71], v[84:87], v[100:103], v[56:71]
    s_sub_u32 s68, s68, 1
    s_cmp_lg_u32 s68, 0
    v_mfma_f32_32x32x16_bf16 v[40:55], v[84:87], v[96:99], v[40:55]
    s_cbranch_scc1 L_cloop_109
    s_waitcnt lgkmcnt(0)
    s_setprio 1
    s_mov_b32 s76, 0
    v_pk_mul_f32 v[160:161], v[8:9], v[8:9]
    v_pk_mul_f32 v[162:163], v[10:11], v[10:11]
    v_pk_mul_f32 v[164:165], v[12:13], v[12:13]
    v_pk_mul_f32 v[166:167], v[14:15], v[14:15]
    v_pk_fma_f32 v[160:161], v[160:161], s[72:73], v[126:127]
    v_pk_fma_f32 v[162:163], v[162:163], s[72:73], v[126:127]
    v_pk_fma_f32 v[164:165], v[164:165], s[72:73], v[126:127]
    v_pk_fma_f32 v[166:167], v[166:167], s[72:73], v[126:127]
    v_pk_mul_f32 v[160:161], v[160:161], v[8:9]
    v_pk_mul_f32 v[162:163], v[162:163], v[10:11]
    v_pk_mul_f32 v[164:165], v[164:165], v[12:13]
    v_pk_mul_f32 v[166:167], v[166:167], v[14:15]
    v_exp_f32 v160, v160
    v_exp_f32 v161, v161
    v_exp_f32 v162, v162
    v_exp_f32 v163, v163
    v_exp_f32 v164, v164
    v_exp_f32 v165, v165
    v_exp_f32 v166, v166
    v_exp_f32 v167, v167
    s_nop 0
    v_pk_add_f32 v[160:161], v[160:161], s[74:75]
    v_pk_add_f32 v[162:163], v[162:163], s[74:75]
    v_pk_add_f32 v[164:165], v[164:165], s[74:75]
    v_pk_add_f32 v[166:167], v[166:167], s[74:75]
    v_rcp_f32 v160, v160
    v_rcp_f32 v161, v161
    v_rcp_f32 v162, v162
    v_rcp_f32 v163, v163
    v_rcp_f32 v164, v164
    v_rcp_f32 v165, v165
    v_rcp_f32 v166, v166
    v_rcp_f32 v167, v167
    s_nop 0
    v_pk_mul_f32 v[160:161], v[160:161], v[8:9]
    v_pk_mul_f32 v[162:163], v[162:163], v[10:11]
    v_pk_mul_f32 v[164:165], v[164:165], v[12:13]
    v_pk_mul_f32 v[166:167], v[166:167], v[14:15]
    v_cvt_pk_bf16_f32 v128, v160, v161
    v_cvt_pk_bf16_f32 v129, v162, v163
    v_cvt_pk_bf16_f32 v130, v164, v165
    v_cvt_pk_bf16_f32 v131, v166, v167
    buffer_store_dwordx4 v[128:131], v123, s[48:51], s76 offen offset:0 sc1
    ds_write_b128 v124, v[128:131] offset:0
    v_pk_mul_f32 v[160:161], v[24:25], v[24:25]
    v_pk_mul_f32 v[162:163], v[26:27], v[26:27]
    v_pk_mul_f32 v[164:165], v[28:29], v[28:29]
    v_pk_mul_f32 v[166:167], v[30:31], v[30:31]
    v_pk_fma_f32 v[160:161], v[160:161], s[72:73], v[126:127]
    v_pk_fma_f32 v[162:163], v[162:163], s[72:73], v[126:127]
    v_pk_fma_f32 v[164:165], v[164:165], s[72:73], v[126:127]
    v_pk_fma_f32 v[166:167], v[166:167], s[72:73], v[126:127]
    v_pk_mul_f32 v[160:161], v[160:161], v[24:25]
    v_pk_mul_f32 v[162:163], v[162:163], v[26:27]
    v_pk_mul_f32 v[164:165], v[164:165], v[28:29]
    v_pk_mul_f32 v[166:167], v[166:167], v[30:31]
    v_exp_f32 v160, v160
    v_exp_f32 v161, v161
    v_exp_f32 v162, v162
    v_exp_f32 v163, v163
    v_exp_f32 v164, v164
    v_exp_f32 v165, v165
    v_exp_f32 v166, v166
    v_exp_f32 v167, v167
    s_nop 0
    v_pk_add_f32 v[160:161], v[160:161], s[74:75]
    v_pk_add_f32 v[162:163], v[162:163], s[74:75]
    v_pk_add_f32 v[164:165], v[164:165], s[74:75]
    v_pk_add_f32 v[166:167], v[166:167], s[74:75]
    v_rcp_f32 v160, v160
    v_rcp_f32 v161, v161
    v_rcp_f32 v162, v162
    v_rcp_f32 v163, v163
    v_rcp_f32 v164, v164
    v_rcp_f32 v165, v165
    v_rcp_f32 v166, v166
    v_rcp_f32 v167, v167
    s_nop 0
    v_pk_mul_f32 v[160:161], v[160:161], v[24:25]
    v_pk_mul_f32 v[162:163], v[162:163], v[26:27]
    v_pk_mul_f32 v[164:165], v[164:165], v[28:29]
    v_pk_mul_f32 v[166:167], v[166:167], v[30:31]
    v_cvt_pk_bf16_f32 v132, v160, v161
    v_cvt_pk_bf16_f32 v133, v162, v163
    v_cvt_pk_bf16_f32 v134, v164, v165
    v_cvt_pk_bf16_f32 v135, v166, v167
    buffer_store_dwordx4 v[132:135], v123, s[48:51], s76 offen offset:512 sc1
    ds_write_b128 v124, v[132:135] offset:512
    s_mov_b32 s76, 32768
    v_pk_mul_f32 v[160:161], v[16:17], v[16:17]
    v_pk_mul_f32 v[162:163], v[18:19], v[18:19]
    v_pk_mul_f32 v[164:165], v[20:21], v[20:21]
    v_pk_mul_f32 v[166:167], v[22:23], v[22:23]
    v_pk_fma_f32 v[160:161], v[160:161], s[72:73], v[126:127]
    v_pk_fma_f32 v[162:163], v[162:163], s[72:73], v[126:127]
    v_pk_fma_f32 v[164:165], v[164:165], s[72:73], v[126:127]
    v_pk_fma_f32 v[166:167], v[166:167], s[72:73], v[126:127]
    v_pk_mul_f32 v[160:161], v[160:161], v[16:17]
    v_pk_mul_f32 v[162:163], v[162:163], v[18:19]
    v_pk_mul_f32 v[164:165], v[164:165], v[20:21]
    v_pk_mul_f32 v[166:167], v[166:167], v[22:23]
    v_exp_f32 v160, v160
    v_exp_f32 v161, v161
    v_exp_f32 v162, v162
    v_exp_f32 v163, v163
    v_exp_f32 v164, v164
    v_exp_f32 v165, v165
    v_exp_f32 v166, v166
    v_exp_f32 v167, v167
    s_nop 0
    v_pk_add_f32 v[160:161], v[160:161], s[74:75]
    v_pk_add_f32 v[162:163], v[162:163], s[74:75]
    v_pk_add_f32 v[164:165], v[164:165], s[74:75]
    v_pk_add_f32 v[166:167], v[166:167], s[74:75]
    v_rcp_f32 v160, v160
    v_rcp_f32 v161, v161
    v_rcp_f32 v162, v162
    v_rcp_f32 v163, v163
    v_rcp_f32 v164, v164
    v_rcp_f32 v165, v165
    v_rcp_f32 v166, v166
    v_rcp_f32 v167, v167
    s_nop 0
    v_pk_mul_f32 v[160:161], v[160:161], v[16:17]
    v_pk_mul_f32 v[162:163], v[162:163], v[18:19]
    v_pk_mul_f32 v[164:165], v[164:165], v[20:21]
    v_pk_mul_f32 v[166:167], v[166:167], v[22:23]
    v_cvt_pk_bf16_f32 v128, v160, v161
    v_cvt_pk_bf16_f32 v129, v162, v163
    v_cvt_pk_bf16_f32 v130, v164, v165
    v_cvt_pk_bf16_f32 v131, v166, v167
    buffer_store_dwordx4 v[128:131], v123, s[48:51], s76 offen offset:0 sc1
    ds_write_b128 v124, v[128:131] offset:4096
    v_pk_mul_f32 v[160:161], v[32:33], v[32:33]
    v_pk_mul_f32 v[162:163], v[34:35], v[34:35]
    v_pk_mul_f32 v[164:165], v[36:37], v[36:37]
    v_pk_mul_f32 v[166:167], v[38:39], v[38:39]
    v_pk_fma_f32 v[160:161], v[160:161], s[72:73], v[126:127]
    v_pk_fma_f32 v[162:163], v[162:163], s[72:73], v[126:127]
    v_pk_fma_f32 v[164:165], v[164:165], s[72:73], v[126:127]
    v_pk_fma_f32 v[166:167], v[166:167], s[72:73], v[126:127]
    v_pk_mul_f32 v[160:161], v[160:161], v[32:33]
    v_pk_mul_f32 v[162:163], v[162:163], v[34:35]
    v_pk_mul_f32 v[164:165], v[164:165], v[36:37]
    v_pk_mul_f32 v[166:167], v[166:167], v[38:39]
    v_exp_f32 v160, v160
    v_exp_f32 v161, v161
    v_exp_f32 v162, v162
    v_exp_f32 v163, v163
    v_exp_f32 v164, v164
    v_exp_f32 v165, v165
    v_exp_f32 v166, v166
    v_exp_f32 v167, v167
    s_nop 0
    v_pk_add_f32 v[160:161], v[160:161], s[74:75]
    v_pk_add_f32 v[162:163], v[162:163], s[74:75]
    v_pk_add_f32 v[164:165], v[164:165], s[74:75]
    v_pk_add_f32 v[166:167], v[166:167], s[74:75]
    v_rcp_f32 v160, v160
    v_rcp_f32 v161, v161
    v_rcp_f32 v162, v162
    v_rcp_f32 v163, v163
    v_rcp_f32 v164, v164
    v_rcp_f32 v165, v165
    v_rcp_f32 v166, v166
    v_rcp_f32 v167, v167
    s_nop 0
    v_pk_mul_f32 v[160:161], v[160:161], v[32:33]
    v_pk_mul_f32 v[162:163], v[162:163], v[34:35]
    v_pk_mul_f32 v[164:165], v[164:165], v[36:37]
    v_pk_mul_f32 v[166:167], v[166:167], v[38:39]
    v_cvt_pk_bf16_f32 v132, v160, v161
    v_cvt_pk_bf16_f32 v133, v162, v163
    v_cvt_pk_bf16_f32 v134, v164, v165
    v_cvt_pk_bf16_f32 v135, v166, v167
    buffer_store_dwordx4 v[132:135], v123, s[48:51], s76 offen offset:512 sc1
    ds_write_b128 v124, v[132:135] offset:4608
    s_mov_b32 s76, 65536
    v_pk_mul_f32 v[160:161], v[40:41], v[40:41]
    v_pk_mul_f32 v[162:163], v[42:43], v[42:43]
    v_pk_mul_f32 v[164:165], v[44:45], v[44:45]
    v_pk_mul_f32 v[166:167], v[46:47], v[46:47]
    v_pk_fma_f32 v[160:161], v[160:161], s[72:73], v[126:127]
    v_pk_fma_f32 v[162:163], v[162:163], s[72:73], v[126:127]
    v_pk_fma_f32 v[164:165], v[164:165], s[72:73], v[126:127]
    v_pk_fma_f32 v[166:167], v[166:167], s[72:73], v[126:127]
    v_pk_mul_f32 v[160:161], v[160:161], v[40:41]
    v_pk_mul_f32 v[162:163], v[162:163], v[42:43]
    v_pk_mul_f32 v[164:165], v[164:165], v[44:45]
    v_pk_mul_f32 v[166:167], v[166:167], v[46:47]
    v_exp_f32 v160, v160
    v_exp_f32 v161, v161
    v_exp_f32 v162, v162
    v_exp_f32 v163, v163
    v_exp_f32 v164, v164
    v_exp_f32 v165, v165
    v_exp_f32 v166, v166
    v_exp_f32 v167, v167
    s_nop 0
    v_pk_add_f32 v[160:161], v[160:161], s[74:75]
    v_pk_add_f32 v[162:163], v[162:163], s[74:75]
    v_pk_add_f32 v[164:165], v[164:165], s[74:75]
    v_pk_add_f32 v[166:167], v[166:167], s[74:75]
    v_rcp_f32 v160, v160
    v_rcp_f32 v161, v161
    v_rcp_f32 v162, v162
    v_rcp_f32 v163, v163
    v_rcp_f32 v164, v164
    v_rcp_f32 v165, v165
    v_rcp_f32 v166, v166
    v_rcp_f32 v167, v167
    s_nop 0
    v_pk_mul_f32 v[160:161], v[160:161], v[40:41]
    v_pk_mul_f32 v[162:163], v[162:163], v[42:43]
    v_pk_mul_f32 v[164:165], v[164:165], v[44:45]
    v_pk_mul_f32 v[166:167], v[166:167], v[46:47]
    v_cvt_pk_bf16_f32 v128, v160, v161
    v_cvt_pk_bf16_f32 v129, v162, v163
    v_cvt_pk_bf16_f32 v130, v164, v165
    v_cvt_pk_bf16_f32 v131, v166, v167
    buffer_store_dwordx4 v[128:131], v123, s[48:51], s76 offen offset:0 sc1
    ds_write_b128 v124, v[128:131] offset:8192
    v_pk_mul_f32 v[160:161], v[56:57], v[56:57]
    v_pk_mul_f32 v[162:163], v[58:59], v[58:59]
    v_pk_mul_f32 v[164:165], v[60:61], v[60:61]
    v_pk_mul_f32 v[166:167], v[62:63], v[62:63]
    v_pk_fma_f32 v[160:161], v[160:161], s[72:73], v[126:127]
    v_pk_fma_f32 v[162:163], v[162:163], s[72:73], v[126:127]
    v_pk_fma_f32 v[164:165], v[164:165], s[72:73], v[126:127]
    v_pk_fma_f32 v[166:167], v[166:167], s[72:73], v[126:127]
    v_pk_mul_f32 v[160:161], v[160:161], v[56:57]
    v_pk_mul_f32 v[162:163], v[162:163], v[58:59]
    v_pk_mul_f32 v[164:165], v[164:165], v[60:61]
    v_pk_mul_f32 v[166:167], v[166:167], v[62:63]
    v_exp_f32 v160, v160
    v_exp_f32 v161, v161
    v_exp_f32 v162, v162
    v_exp_f32 v163, v163
    v_exp_f32 v164, v164
    v_exp_f32 v165, v165
    v_exp_f32 v166, v166
    v_exp_f32 v167, v167
    s_nop 0
    v_pk_add_f32 v[160:161], v[160:161], s[74:75]
    v_pk_add_f32 v[162:163], v[162:163], s[74:75]
    v_pk_add_f32 v[164:165], v[164:165], s[74:75]
    v_pk_add_f32 v[166:167], v[166:167], s[74:75]
    v_rcp_f32 v160, v160
    v_rcp_f32 v161, v161
    v_rcp_f32 v162, v162
    v_rcp_f32 v163, v163
    v_rcp_f32 v164, v164
    v_rcp_f32 v165, v165
    v_rcp_f32 v166, v166
    v_rcp_f32 v167, v167
    s_nop 0
    v_pk_mul_f32 v[160:161], v[160:161], v[56:57]
    v_pk_mul_f32 v[162:163], v[162:163], v[58:59]
    v_pk_mul_f32 v[164:165], v[164:165], v[60:61]
    v_pk_mul_f32 v[166:167], v[166:167], v[62:63]
    v_cvt_pk_bf16_f32 v132, v160, v161
    v_cvt_pk_bf16_f32 v133, v162, v163
    v_cvt_pk_bf16_f32 v134, v164, v165
    v_cvt_pk_bf16_f32 v135, v166, v167
    buffer_store_dwordx4 v[132:135], v123, s[48:51], s76 offen offset:512 sc1
    ds_write_b128 v124, v[132:135] offset:8704
    s_mov_b32 s76, 98304
    v_pk_mul_f32 v[160:161], v[48:49], v[48:49]
    v_pk_mul_f32 v[162:163], v[50:51], v[50:51]
    v_pk_mul_f32 v[164:165], v[52:53], v[52:53]
    v_pk_mul_f32 v[166:167], v[54:55], v[54:55]
    v_pk_fma_f32 v[160:161], v[160:161], s[72:73], v[126:127]
    v_pk_fma_f32 v[162:163], v[162:163], s[72:73], v[126:127]
    v_pk_fma_f32 v[164:165], v[164:165], s[72:73], v[126:127]
    v_pk_fma_f32 v[166:167], v[166:167], s[72:73], v[126:127]
    v_pk_mul_f32 v[160:161], v[160:161], v[48:49]
    v_pk_mul_f32 v[162:163], v[162:163], v[50:51]
    v_pk_mul_f32 v[164:165], v[164:165], v[52:53]
    v_pk_mul_f32 v[166:167], v[166:167], v[54:55]
    v_exp_f32 v160, v160
    v_exp_f32 v161, v161
    v_exp_f32 v162, v162
    v_exp_f32 v163, v163
    v_exp_f32 v164, v164
    v_exp_f32 v165, v165
    v_exp_f32 v166, v166
    v_exp_f32 v167, v167
    s_nop 0
    v_pk_add_f32 v[160:161], v[160:161], s[74:75]
    v_pk_add_f32 v[162:163], v[162:163], s[74:75]
    v_pk_add_f32 v[164:165], v[164:165], s[74:75]
    v_pk_add_f32 v[166:167], v[166:167], s[74:75]
    v_rcp_f32 v160, v160
    v_rcp_f32 v161, v161
    v_rcp_f32 v162, v162
    v_rcp_f32 v163, v163
    v_rcp_f32 v164, v164
    v_rcp_f32 v165, v165
    v_rcp_f32 v166, v166
    v_rcp_f32 v167, v167
    s_nop 0
    v_pk_mul_f32 v[160:161], v[160:161], v[48:49]
    v_pk_mul_f32 v[162:163], v[162:163], v[50:51]
    v_pk_mul_f32 v[164:165], v[164:165], v[52:53]
    v_pk_mul_f32 v[166:167], v[166:167], v[54:55]
    v_cvt_pk_bf16_f32 v128, v160, v161
    v_cvt_pk_bf16_f32 v129, v162, v163
    v_cvt_pk_bf16_f32 v130, v164, v165
    v_cvt_pk_bf16_f32 v131, v166, v167
    buffer_store_dwordx4 v[128:131], v123, s[48:51], s76 offen offset:0 sc1
    ds_write_b128 v124, v[128:131] offset:12288
    v_pk_mul_f32 v[160:161], v[64:65], v[64:65]
    v_pk_mul_f32 v[162:163], v[66:67], v[66:67]
    v_pk_mul_f32 v[164:165], v[68:69], v[68:69]
    v_pk_mul_f32 v[166:167], v[70:71], v[70:71]
    v_pk_fma_f32 v[160:161], v[160:161], s[72:73], v[126:127]
    v_pk_fma_f32 v[162:163], v[162:163], s[72:73], v[126:127]
    v_pk_fma_f32 v[164:165], v[164:165], s[72:73], v[126:127]
    v_pk_fma_f32 v[166:167], v[166:167], s[72:73], v[126:127]
    v_pk_mul_f32 v[160:161], v[160:161], v[64:65]
    v_pk_mul_f32 v[162:163], v[162:163], v[66:67]
    v_pk_mul_f32 v[164:165], v[164:165], v[68:69]
    v_pk_mul_f32 v[166:167], v[166:167], v[70:71]
    v_exp_f32 v160, v160
    v_exp_f32 v161, v161
    v_exp_f32 v162, v162
    v_exp_f32 v163, v163
    v_exp_f32 v164, v164
    v_exp_f32 v165, v165
    v_exp_f32 v166, v166
    v_exp_f32 v167, v167
    s_nop 0
    v_pk_add_f32 v[160:161], v[160:161], s[74:75]
    v_pk_add_f32 v[162:163], v[162:163], s[74:75]
    v_pk_add_f32 v[164:165], v[164:165], s[74:75]
    v_pk_add_f32 v[166:167], v[166:167], s[74:75]
    v_rcp_f32 v160, v160
    v_rcp_f32 v161, v161
    v_rcp_f32 v162, v162
    v_rcp_f32 v163, v163
    v_rcp_f32 v164, v164
    v_rcp_f32 v165, v165
    v_rcp_f32 v166, v166
    v_rcp_f32 v167, v167
    s_nop 0
    v_pk_mul_f32 v[160:161], v[160:161], v[64:65]
    v_pk_mul_f32 v[162:163], v[162:163], v[66:67]
    v_pk_mul_f32 v[164:165], v[164:165], v[68:69]
    v_pk_mul_f32 v[166:167], v[166:167], v[70:71]
    v_cvt_pk_bf16_f32 v132, v160, v161
    v_cvt_pk_bf16_f32 v133, v162, v163
    v_cvt_pk_bf16_f32 v134, v164, v165
    v_cvt_pk_bf16_f32 v135, v166, v167
    buffer_store_dwordx4 v[132:135], v123, s[48:51], s76 offen offset:512 sc1
    ds_write_b128 v124, v[132:135] offset:12800
    s_waitcnt vmcnt(0)
    s_mov_b64 exec, 1
    ds_add_rtn_u32 v2, v111, v3 offset:16
    s_waitcnt lgkmcnt(0)
    v_readfirstlane_b32 s58, v2
    s_cmp_lg_u32 s58, 3
    s_cbranch_scc1 L_nl_110
    v_mov_b32 v2, s31
    buffer_store_dword v2, v110, s[24:27], 0 offen sc1
L_nl_110:
    s_mov_b64 exec, -1
L_seamC_5:
    s_waitcnt lgkmcnt(0)
    s_barrier
    ds_read_b64_tr_b16 v[72:73], v107 offset:0
    ds_read_b64_tr_b16 v[74:75], v107 offset:1024
    ds_read_b128 v[88:91], v109 offset:0
    ds_read_b128 v[92:95], v109 offset:512
    ds_read_b64_tr_b16 v[76:77], v108 offset:0
    ds_read_b64_tr_b16 v[78:79], v108 offset:1024
    s_mov_b32 s68, 28
    s_waitcnt lgkmcnt(3)
    v_mfma_f32_32x32x16_bf16 v[8:23], v[88:91], v[72:75], 0
    ds_read_b64_tr_b16 v[80:81], v107 offset:4096
    ds_read_b64_tr_b16 v[82:83], v107 offset:5120
    ds_read_b128 v[96:99], v109 offset:4096
    s_waitcnt lgkmcnt(5)
    v_mfma_f32_32x32x16_bf16 v[24:39], v[92:95], v[72:75], 0
    ds_read_b128 v[100:103], v109 offset:4608
    ds_read_b64_tr_b16 v[84:85], v108 offset:4096
    ds_read_b64_tr_b16 v[86:87], v108 offset:5120
    s_waitcnt lgkmcnt(6)
    v_mfma_f32_32x32x16_bf16 v[56:71], v[92:95], v[76:79], 0
    v_mfma_f32_32x32x16_bf16 v[40:55], v[88:91], v[76:79], 0
    s_branch L_cloop_111_1
.p2align 6
L_cloop_111:
    s_waitcnt lgkmcnt(3)
    v_mfma_f32_32x32x16_bf16 v[8:23], v[88:91], v[72:75], v[8:23]
    ds_read_b64_tr_b16 v[80:81], v107 offset:4096
    ds_read_b64_tr_b16 v[82:83], v107 offset:5120
    ds_read_b128 v[96:99], v109 offset:4096
    s_waitcnt lgkmcnt(5)
    v_mfma_f32_32x32x16_bf16 v[24:39], v[92:95], v[72:75], v[24:39]
    ds_read_b128 v[100:103], v109 offset:4608
    ds_read_b64_tr_b16 v[84:85], v108 offset:4096
    ds_read_b64_tr_b16 v[86:87], v108 offset:5120
    s_waitcnt lgkmcnt(6)
    v_mfma_f32_32x32x16_bf16 v[56:71], v[92:95], v[76:79], v[56:71]
    v_mfma_f32_32x32x16_bf16 v[40:55], v[88:91], v[76:79], v[40:55]
L_cloop_111_1:
    s_waitcnt lgkmcnt(3)
    v_mfma_f32_32x32x16_bf16 v[8:23], v[96:99], v[80:83], v[8:23]
    ds_read_b64_tr_b16 v[72:73], v107 offset:8192
    ds_read_b64_tr_b16 v[74:75], v107 offset:9216
    ds_read_b128 v[88:91], v109 offset:8192
    s_waitcnt lgkmcnt(5)
    v_mfma_f32_32x32x16_bf16 v[24:39], v[100:103], v[80:83], v[24:39]
    ds_read_b128 v[92:95], v109 offset:8704
    ds_read_b64_tr_b16 v[76:77], v108 offset:8192
    ds_read_b64_tr_b16 v[78:79], v108 offset:9216
    s_waitcnt lgkmcnt(6)
    v_mfma_f32_32x32x16_bf16 v[56:71], v[100:103], v[84:87], v[56:71]
    v_mfma_f32_32x32x16_bf16 v[40:55], v[96:99], v[84:87], v[40:55]
    s_waitcnt lgkmcnt(3)
    v_mfma_f32_32x32x16_bf16 v[8:23], v[88:91], v[72:75], v[8:23]
    ds_read_b64_tr_b16 v[80:81], v107 offset:12288
    ds_read_b64_tr_b16 v[82:83], v107 offset:13312
    ds_read_b128 v[96:99], v109 offset:12288
    s_waitcnt lgkmcnt(5)
    v_mfma_f32_32x32x16_bf16 v[24:39], v[92:95], v[72:75], v[24:39]
    ds_read_b128 v[100:103], v109 offset:12800
    ds_read_b64_tr_b16 v[84:85], v108 offset:12288
    ds_read_b64_tr_b16 v[86:87], v108 offset:13312
    s_waitcnt lgkmcnt(6)
    v_mfma_f32_32x32x16_bf16 v[56:71], v[92:95], v[76:79], v[56:71]
    v_mfma_f32_32x32x16_bf16 v[40:55], v[88:91], v[76:79], v[40:55]
    s_add_u32 s67, s67, 32768
    s_cmp_ge_u32 s67, 98304
    s_cselect_b32 s67, 0, s67
    v_add_u32 v107, s67, v104
    v_add_u32 v108, s67, v105
    v_add_u32 v109, s67, v106
    s_waitcnt lgkmcnt(0)
    s_barrier
    v_mfma_f32_32x32x16_bf16 v[8:23], v[96:99], v[80:83], v[8:23]
    ds_read_b64_tr_b16 v[72:73], v107 offset:0
    ds_read_b64_tr_b16 v[74:75], v107 offset:1024
    ds_read_b128 v[88:91], v109 offset:0
    v_mfma_f32_32x32x16_bf16 v[24:39], v[100:103], v[80:83], v[24:39]
    ds_read_b128 v[92:95], v109 offset:512
    ds_read_b64_tr_b16 v[76:77], v108 offset:0
    ds_read_b64_tr_b16 v[78:79], v108 offset:1024
    v_mfma_f32_32x32x16_bf16 v[56:71], v[100:103], v[84:87], v[56:71]
    s_sub_u32 s68, s68, 1
    s_cmp_lg_u32 s68, 0
    v_mfma_f32_32x32x16_bf16 v[40:55], v[96:99], v[84:87], v[40:55]
    s_cbranch_scc1 L_cloop_111
    s_waitcnt lgkmcnt(0)
    s_cmp_eq_u32 s63, 1
    s_cbranch_scc1 L_e1_112
    s_nop 7
    v_cvt_pk_bf16_f32 v128, v40, v41
    v_cvt_pk_bf16_f32 v129, v42, v43
    v_cvt_pk_bf16_f32 v130, v44, v45
    v_cvt_pk_bf16_f32 v131, v46, v47
    v_cvt_pk_bf16_f32 v132, v48, v49
    v_cvt_pk_bf16_f32 v133, v50, v51
    v_cvt_pk_bf16_f32 v134, v52, v53
    v_cvt_pk_bf16_f32 v135, v54, v55
    v_cvt_pk_bf16_f32 v136, v56, v57
    v_cvt_pk_bf16_f32 v137, v58, v59
    v_cvt_pk_bf16_f32 v138, v60, v61
    v_cvt_pk_bf16_f32 v139, v62, v63
    v_cvt_pk_bf16_f32 v140, v64, v65
    v_cvt_pk_bf16_f32 v141, v66, v67
    v_cvt_pk_bf16_f32 v142, v68, v69
    v_cvt_pk_bf16_f32 v143, v70, v71
    buffer_store_dwordx4 v[128:131], v113, s[40:43], s69 offen offset:0 sc1
    buffer_store_dwordx4 v[132:135], v113, s[40:43], s69 offen offset:1024 sc1
    buffer_store_dwordx4 v[136:139], v113, s[40:43], s69 offen offset:2048 sc1
    buffer_store_dwordx4 v[140:143], v113, s[40:43], s69 offen offset:3072 sc1
    ds_read_b64 v[160:161], v115
    ds_read_b64 v[162:163], v116
    ds_read_b64 v[164:165], v117
    ds_read_b64 v[166:167], v118
    ds_read_b64 v[168:169], v119
    ds_read_b64 v[170:171], v120
    ds_read_b64 v[172:173], v121
    ds_read_b64 v[174:175], v122
    v_mov_b32 v2, s31
    s_xor_b32 s69, s69, 131072
    s_xor_b32 s70, s70, 131072
    s_waitcnt vmcnt(0)
    buffer_store_dword v2, v114, s[24:27], 0 offen sc1
    v_xor_b32 v114, 2048, v114
    buffer_load_dword v3, v114, s[24:27], 0 offen sc1
    s_waitcnt lgkmcnt(0)
    v_lshlrev_b32 v176, 16, v176
    v_lshlrev_b32 v40, 16, v160
    v_and_b32 v41, 0xffff0000, v160
    v_lshlrev_b32 v42, 16, v161
    v_and_b32 v43, 0xffff0000, v161
    v_lshlrev_b32 v44, 16, v162
    v_and_b32 v45, 0xffff0000, v162
    v_lshlrev_b32 v46, 16, v163
    v_and_b32 v47, 0xffff0000, v163
    v_lshlrev_b32 v48, 16, v164
    v_and_b32 v49, 0xffff0000, v164
    v_lshlrev_b32 v50, 16, v165
    v_and_b32 v51, 0xffff0000, v165
    v_lshlrev_b32 v52, 16, v166
    v_and_b32 v53, 0xffff0000, v166
    v_lshlrev_b32 v54, 16, v167
    v_and_b32 v55, 0xffff0000, v167
    v_lshlrev_b32 v56, 16, v168
    v_and_b32 v57, 0xffff0000, v168
    v_lshlrev_b32 v58, 16, v169
    v_and_b32 v59, 0xffff0000, v169
    v_lshlrev_b32 v60, 16, v170
    v_and_b32 v61, 0xffff0000, v170
    v_lshlrev_b32 v62, 16, v171
    v_and_b32 v63, 0xffff0000, v171
    v_lshlrev_b32 v64, 16, v172
    v_and_b32 v65, 0xffff0000, v172
    v_lshlrev_b32 v66, 16, v173
    v_and_b32 v67, 0xffff0000, v173
    v_lshlrev_b32 v68, 16, v174
    v_and_b32 v69, 0xffff0000, v174
    v_lshlrev_b32 v70, 16, v175
    v_and_b32 v71, 0xffff0000, v175
    v_add_f32 v40, v176, v40
    v_add_f32 v8, v8, v40
    v_add_f32 v41, v176, v41
    v_add_f32 v9, v9, v41
    v_add_f32 v42, v176, v42
    v_add_f32 v10, v10, v42
    v_add_f32 v43, v176, v43
    v_add_f32 v11, v11, v43
    v_add_f32 v44, v176, v44
    v_add_f32 v12, v12, v44
    v_add_f32 v45, v176, v45
    v_add_f32 v13, v13, v45
    v_add_f32 v46, v176, v46
    v_add_f32 v14, v14, v46
    v_add_f32 v47, v176, v47
    v_add_f32 v15, v15, v47
    v_add_f32 v48, v176, v48
    v_add_f32 v16, v16, v48
    v_add_f32 v49, v176, v49
    v_add_f32 v17, v17, v49
    v_add_f32 v50, v176, v50
    v_add_f32 v18, v18, v50
    v_add_f32 v51, v176, v51
    v_add_f32 v19, v19, v51
    v_add_f32 v52, v176, v52
    v_add_f32 v20, v20, v52
    v_add_f32 v53, v176, v53
    v_add_f32 v21, v21, v53
    v_add_f32 v54, v176, v54
    v_add_f32 v22, v22, v54
    v_add_f32 v55, v176, v55
    v_add_f32 v23, v23, v55
    v_add_f32 v56, v176, v56
    v_add_f32 v24, v24, v56
    v_add_f32 v57, v176, v57
    v_add_f32 v25, v25, v57
    v_add_f32 v58, v176, v58
    v_add_f32 v26, v26, v58
    v_add_f32 v59, v176, v59
    v_add_f32 v27, v27, v59
    v_add_f32 v60, v176, v60
    v_add_f32 v28, v28, v60
    v_add_f32 v61, v176, v61
    v_add_f32 v29, v29, v61
    v_add_f32 v62, v176, v62
    v_add_f32 v30, v30, v62
    v_add_f32 v63, v176, v63
    v_add_f32 v31, v31, v63
    v_add_f32 v64, v176, v64
    v_add_f32 v32, v32, v64
    v_add_f32 v65, v176, v65
    v_add_f32 v33, v33, v65
    v_add_f32 v66, v176, v66
    v_add_f32 v34, v34, v66
    v_add_f32 v67, v176, v67
    v_add_f32 v35, v35, v67
    v_add_f32 v68, v176, v68
    v_add_f32 v36, v36, v68
    v_add_f32 v69, v176, v69
    v_add_f32 v37, v37, v69
    v_add_f32 v70, v176, v70
    v_add_f32 v38, v38, v70
    v_add_f32 v71, v176, v71
    v_add_f32 v39, v39, v71
    s_mov_b32 s66, 131072
    s_branch L_pollw_115
L_poll_114:
L_poll_114x:
    buffer_load_dword v3, v114, s[24:27], 0 offen sc1
L_pollw_115:
    s_waitcnt vmcnt(0)
    v_cmp_ne_u32 vcc, s31, v3
    s_sub_u32 s66, s66, 1
    s_cbranch_scc1 L_polld_116
    s_cmp_lg_u64 vcc, 0
    s_cbranch_scc1 L_poll_114
L_polld_116:
    buffer_load_dwordx4 v[160:163], v113, s[40:43], s69 offen offset:0 sc1
    buffer_load_dwordx4 v[164:167], v113, s[40:43], s69 offen offset:1024 sc1
    buffer_load_dwordx4 v[168:171], v113, s[40:43], s69 offen offset:2048 sc1
    buffer_load_dwordx4 v[172:175], v113, s[40:43], s69 offen offset:3072 sc1
    s_waitcnt vmcnt(2)
    v_lshlrev_b32 v128, 16, v160
    v_and_b32 v129, 0xffff0000, v160
    v_lshlrev_b32 v130, 16, v161
    v_and_b32 v131, 0xffff0000, v161
    v_lshlrev_b32 v132, 16, v162
    v_and_b32 v133, 0xffff0000, v162
    v_lshlrev_b32 v134, 16, v163
    v_and_b32 v135, 0xffff0000, v163
    v_lshlrev_b32 v136, 16, v164
    v_and_b32 v137, 0xffff0000, v164
    v_lshlrev_b32 v138, 16, v165
    v_and_b32 v139, 0xffff0000, v165
    v_lshlrev_b32 v140, 16, v166
    v_and_b32 v141, 0xffff0000, v166
    v_lshlrev_b32 v142, 16, v167
    v_and_b32 v143, 0xffff0000, v167
    v_add_f32 v8, v8, v128
    v_add_f32 v9, v9, v129
    v_add_f32 v10, v10, v130
    v_add_f32 v11, v11, v131
    v_add_f32 v12, v12, v132
    v_add_f32 v13, v13, v133
    v_add_f32 v14, v14, v134
    v_add_f32 v15, v15, v135
    v_add_f32 v16, v16, v136
    v_add_f32 v17, v17, v137
    v_add_f32 v18, v18, v138
    v_add_f32 v19, v19, v139
    v_add_f32 v20, v20, v140
    v_add_f32 v21, v21, v141
    v_add_f32 v22, v22, v142
    v_add_f32 v23, v23, v143
    v_cvt_pk_bf16_f32 v40, v8, v9
    v_cvt_pk_bf16_f32 v41, v10, v11
    v_cvt_pk_bf16_f32 v42, v12, v13
    v_cvt_pk_bf16_f32 v43, v14, v15
    v_cvt_pk_bf16_f32 v44, v16, v17
    v_cvt_pk_bf16_f32 v45, v18, v19
    v_cvt_pk_bf16_f32 v46, v20, v21
    v_cvt_pk_bf16_f32 v47, v22, v23
    v_permlane32_swap_b32 v40, v42
    v_permlane32_swap_b32 v41, v43
    buffer_store_dwordx4 v[40:43], v112, s[36:39], s59 offen offset:0
    v_permlane32_swap_b32 v44, v46
    v_permlane32_swap_b32 v45, v47
    buffer_store_dwordx4 v[44:47], v112, s[36:39], s59 offen offset:32
    s_waitcnt vmcnt(2)
    v_lshlrev_b32 v144, 16, v168
    v_and_b32 v145, 0xffff0000, v168
    v_lshlrev_b32 v146, 16, v169
    v_and_b32 v147, 0xffff0000, v169
    v_lshlrev_b32 v148, 16, v170
    v_and_b32 v149, 0xffff0000, v170
    v_lshlrev_b32 v150, 16, v171
    v_and_b32 v151, 0xffff0000, v171
    v_lshlrev_b32 v152, 16, v172
    v_and_b32 v153, 0xffff0000, v172
    v_lshlrev_b32 v154, 16, v173
    v_and_b32 v155, 0xffff0000, v173
    v_lshlrev_b32 v156, 16, v174
    v_and_b32 v157, 0xffff0000, v174
    v_lshlrev_b32 v158, 16, v175
    v_and_b32 v159, 0xffff0000, v175
    v_add_f32 v24, v24, v144
    v_add_f32 v25, v25, v145
    v_add_f32 v26, v26, v146
    v_add_f32 v27, v27, v147
    v_add_f32 v28, v28, v148
    v_add_f32 v29, v29, v149
    v_add_f32 v30, v30, v150
    v_add_f32 v31, v31, v151
    v_add_f32 v32, v32, v152
    v_add_f32 v33, v33, v153
    v_add_f32 v34, v34, v154
    v_add_f32 v35, v35, v155
    v_add_f32 v36, v36, v156
    v_add_f32 v37, v37, v157
    v_add_f32 v38, v38, v158
    v_add_f32 v39, v39, v159
    v_cvt_pk_bf16_f32 v48, v24, v25
    v_cvt_pk_bf16_f32 v49, v26, v27
    v_cvt_pk_bf16_f32 v50, v28, v29
    v_cvt_pk_bf16_f32 v51, v30, v31
    v_cvt_pk_bf16_f32 v52, v32, v33
    v_cvt_pk_bf16_f32 v53, v34, v35
    v_cvt_pk_bf16_f32 v54, v36, v37
    v_cvt_pk_bf16_f32 v55, v38, v39
    v_permlane32_swap_b32 v48, v50
    v_permlane32_swap_b32 v49, v51
    buffer_store_dwordx4 v[48:51], v112, s[36:39], s59 offen offset:64
    v_permlane32_swap_b32 v52, v54
    v_permlane32_swap_b32 v53, v55
    buffer_store_dwordx4 v[52:55], v112, s[36:39], s59 offen offset:96
    s_branch L_e2_113
L_e1_112:
    v_cvt_pk_bf16_f32 v128, v8, v9
    v_cvt_pk_bf16_f32 v129, v10, v11
    v_cvt_pk_bf16_f32 v130, v12, v13
    v_cvt_pk_bf16_f32 v131, v14, v15
    v_cvt_pk_bf16_f32 v132, v16, v17
    v_cvt_pk_bf16_f32 v133, v18, v19
    v_cvt_pk_bf16_f32 v134, v20, v21
    v_cvt_pk_bf16_f32 v135, v22, v23
    v_cvt_pk_bf16_f32 v136, v24, v25
    v_cvt_pk_bf16_f32 v137, v26, v27
    v_cvt_pk_bf16_f32 v138, v28, v29
    v_cvt_pk_bf16_f32 v139, v30, v31
    v_cvt_pk_bf16_f32 v140, v32, v33
    v_cvt_pk_bf16_f32 v141, v34, v35
    v_cvt_pk_bf16_f32 v142, v36, v37
    v_cvt_pk_bf16_f32 v143, v38, v39
    buffer_store_dwordx4 v[128:131], v113, s[40:43], s69 offen offset:0 sc1
    buffer_store_dwordx4 v[132:135], v113, s[40:43], s69 offen offset:1024 sc1
    buffer_store_dwordx4 v[136:139], v113, s[40:43], s69 offen offset:2048 sc1
    buffer_store_dwordx4 v[140:143], v113, s[40:43], s69 offen offset:3072 sc1
    ds_read_b64 v[160:161], v115
    ds_read_b64 v[162:163], v116
    ds_read_b64 v[164:165], v117
    ds_read_b64 v[166:167], v118
    ds_read_b64 v[168:169], v119
    ds_read_b64 v[170:171], v120
    ds_read_b64 v[172:173], v121
    ds_read_b64 v[174:175], v122
    v_mov_b32 v2, s31
    s_xor_b32 s69, s69, 131072
    s_xor_b32 s70, s70, 131072
    s_waitcnt vmcnt(0)
    buffer_store_dword v2, v114, s[24:27], 0 offen sc1
    v_xor_b32 v114, 2048, v114
    buffer_load_dword v3, v114, s[24:27], 0 offen sc1
    s_waitcnt lgkmcnt(0)
    v_lshlrev_b32 v176, 16, v176
    v_lshlrev_b32 v8, 16, v160
    v_and_b32 v9, 0xffff0000, v160
    v_lshlrev_b32 v10, 16, v161
    v_and_b32 v11, 0xffff0000, v161
    v_lshlrev_b32 v12, 16, v162
    v_and_b32 v13, 0xffff0000, v162
    v_lshlrev_b32 v14, 16, v163
    v_and_b32 v15, 0xffff0000, v163
    v_lshlrev_b32 v16, 16, v164
    v_and_b32 v17, 0xffff0000, v164
    v_lshlrev_b32 v18, 16, v165
    v_and_b32 v19, 0xffff0000, v165
    v_lshlrev_b32 v20, 16, v166
    v_and_b32 v21, 0xffff0000, v166
    v_lshlrev_b32 v22, 16, v167
    v_and_b32 v23, 0xffff0000, v167
    v_lshlrev_b32 v24, 16, v168
    v_and_b32 v25, 0xffff0000, v168
    v_lshlrev_b32 v26, 16, v169
    v_and_b32 v27, 0xffff0000, v169
    v_lshlrev_b32 v28, 16, v170
    v_and_b32 v29, 0xffff0000, v170
    v_lshlrev_b32 v30, 16, v171
    v_and_b32 v31, 0xffff0000, v171
    v_lshlrev_b32 v32, 16, v172
    v_and_b32 v33, 0xffff0000, v172
    v_lshlrev_b32 v34, 16, v173
    v_and_b32 v35, 0xffff0000, v173
    v_lshlrev_b32 v36, 16, v174
    v_and_b32 v37, 0xffff0000, v174
    v_lshlrev_b32 v38, 16, v175
    v_and_b32 v39, 0xffff0000, v175
    v_add_f32 v8, v176, v8
    v_add_f32 v40, v40, v8
    v_add_f32 v9, v176, v9
    v_add_f32 v41, v41, v9
    v_add_f32 v10, v176, v10
    v_add_f32 v42, v42, v10
    v_add_f32 v11, v176, v11
    v_add_f32 v43, v43, v11
    v_add_f32 v12, v176, v12
    v_add_f32 v44, v44, v12
    v_add_f32 v13, v176, v13
    v_add_f32 v45, v45, v13
    v_add_f32 v14, v176, v14
    v_add_f32 v46, v46, v14
    v_add_f32 v15, v176, v15
    v_add_f32 v47, v47, v15
    v_add_f32 v16, v176, v16
    v_add_f32 v48, v48, v16
    v_add_f32 v17, v176, v17
    v_add_f32 v49, v49, v17
    v_add_f32 v18, v176, v18
    v_add_f32 v50, v50, v18
    v_add_f32 v19, v176, v19
    v_add_f32 v51, v51, v19
    v_add_f32 v20, v176, v20
    v_add_f32 v52, v52, v20
    v_add_f32 v21, v176, v21
    v_add_f32 v53, v53, v21
    v_add_f32 v22, v176, v22
    v_add_f32 v54, v54, v22
    v_add_f32 v23, v176, v23
    v_add_f32 v55, v55, v23
    v_add_f32 v24, v176, v24
    v_add_f32 v56, v56, v24
    v_add_f32 v25, v176, v25
    v_add_f32 v57, v57, v25
    v_add_f32 v26, v176, v26
    v_add_f32 v58, v58, v26
    v_add_f32 v27, v176, v27
    v_add_f32 v59, v59, v27
    v_add_f32 v28, v176, v28
    v_add_f32 v60, v60, v28
    v_add_f32 v29, v176, v29
    v_add_f32 v61, v61, v29
    v_add_f32 v30, v176, v30
    v_add_f32 v62, v62, v30
    v_add_f32 v31, v176, v31
    v_add_f32 v63, v63, v31
    v_add_f32 v32, v176, v32
    v_add_f32 v64, v64, v32
    v_add_f32 v33, v176, v33
    v_add_f32 v65, v65, v33
    v_add_f32 v34, v176, v34
    v_add_f32 v66, v66, v34
    v_add_f32 v35, v176, v35
    v_add_f32 v67, v67, v35
    v_add_f32 v36, v176, v36
    v_add_f32 v68, v68, v36
    v_add_f32 v37, v176, v37
    v_add_f32 v69, v69, v37
    v_add_f32 v38, v176, v38
    v_add_f32 v70, v70, v38
    v_add_f32 v39, v176, v39
    v_add_f32 v71, v71, v39
    s_mov_b32 s66, 131072
    s_branch L_pollw_118
L_poll_117:
L_poll_117x:
    buffer_load_dword v3, v114, s[24:27], 0 offen sc1
L_pollw_118:
    s_waitcnt vmcnt(0)
    v_cmp_ne_u32 vcc, s31, v3
    s_sub_u32 s66, s66, 1
    s_cbranch_scc1 L_polld_119
    s_cmp_lg_u64 vcc, 0
    s_cbranch_scc1 L_poll_117
L_polld_119:
    buffer_load_dwordx4 v[160:163], v113, s[40:43], s69 offen offset:0 sc1
    buffer_load_dwordx4 v[164:167], v113, s[40:43], s69 offen offset:1024 sc1
    buffer_load_dwordx4 v[168:171], v113, s[40:43], s69 offen offset:2048 sc1
    buffer_load_dwordx4 v[172:175], v113, s[40:43], s69 offen offset:3072 sc1
    s_waitcnt vmcnt(2)
    v_lshlrev_b32 v128, 16, v160
    v_and_b32 v129, 0xffff0000, v160
    v_lshlrev_b32 v130, 16, v161
    v_and_b32 v131, 0xffff0000, v161
    v_lshlrev_b32 v132, 16, v162
    v_and_b32 v133, 0xffff0000, v162
    v_lshlrev_b32 v134, 16, v163
    v_and_b32 v135, 0xffff0000, v163
    v_lshlrev_b32 v136, 16, v164
    v_and_b32 v137, 0xffff0000, v164
    v_lshlrev_b32 v138, 16, v165
    v_and_b32 v139, 0xffff0000, v165
    v_lshlrev_b32 v140, 16, v166
    v_and_b32 v141, 0xffff0000, v166
    v_lshlrev_b32 v142, 16, v167
    v_and_b32 v143, 0xffff0000, v167
    v_add_f32 v40, v40, v128
    v_add_f32 v41, v41, v129
    v_add_f32 v42, v42, v130
    v_add_f32 v43, v43, v131
    v_add_f32 v44, v44, v132
    v_add_f32 v45, v45, v133
    v_add_f32 v46, v46, v134
    v_add_f32 v47, v47, v135
    v_add_f32 v48, v48, v136
    v_add_f32 v49, v49, v137
    v_add_f32 v50, v50, v138
    v_add_f32 v51, v51, v139
    v_add_f32 v52, v52, v140
    v_add_f32 v53, v53, v141
    v_add_f32 v54, v54, v142
    v_add_f32 v55, v55, v143
    v_cvt_pk_bf16_f32 v8, v40, v41
    v_cvt_pk_bf16_f32 v9, v42, v43
    v_cvt_pk_bf16_f32 v10, v44, v45
    v_cvt_pk_bf16_f32 v11, v46, v47
    v_cvt_pk_bf16_f32 v12, v48, v49
    v_cvt_pk_bf16_f32 v13, v50, v51
    v_cvt_pk_bf16_f32 v14, v52, v53
    v_cvt_pk_bf16_f32 v15, v54, v55
    v_permlane32_swap_b32 v8, v10
    v_permlane32_swap_b32 v9, v11
    buffer_store_dwordx4 v[8:11], v112, s[36:39], s59 offen offset:0
    v_permlane32_swap_b32 v12, v14
    v_permlane32_swap_b32 v13, v15
    buffer_store_dwordx4 v[12:15], v112, s[36:39], s59 offen offset:32
    s_waitcnt vmcnt(2)
    v_lshlrev_b32 v144, 16, v168
    v_and_b32 v145, 0xffff0000, v168
    v_lshlrev_b32 v146, 16, v169
    v_and_b32 v147, 0xffff0000, v169
    v_lshlrev_b32 v148, 16, v170
    v_and_b32 v149, 0xffff0000, v170
    v_lshlrev_b32 v150, 16, v171
    v_and_b32 v151, 0xffff0000, v171
    v_lshlrev_b32 v152, 16, v172
    v_and_b32 v153, 0xffff0000, v172
    v_lshlrev_b32 v154, 16, v173
    v_and_b32 v155, 0xffff0000, v173
    v_lshlrev_b32 v156, 16, v174
    v_and_b32 v157, 0xffff0000, v174
    v_lshlrev_b32 v158, 16, v175
    v_and_b32 v159, 0xffff0000, v175
    v_add_f32 v56, v56, v144
    v_add_f32 v57, v57, v145
    v_add_f32 v58, v58, v146
    v_add_f32 v59, v59, v147
    v_add_f32 v60, v60, v148
    v_add_f32 v61, v61, v149
    v_add_f32 v62, v62, v150
    v_add_f32 v63, v63, v151
    v_add_f32 v64, v64, v152
    v_add_f32 v65, v65, v153
    v_add_f32 v66, v66, v154
    v_add_f32 v67, v67, v155
    v_add_f32 v68, v68, v156
    v_add_f32 v69, v69, v157
    v_add_f32 v70, v70, v158
    v_add_f32 v71, v71, v159
    v_cvt_pk_bf16_f32 v16, v56, v57
    v_cvt_pk_bf16_f32 v17, v58, v59
    v_cvt_pk_bf16_f32 v18, v60, v61
    v_cvt_pk_bf16_f32 v19, v62, v63
    v_cvt_pk_bf16_f32 v20, v64, v65
    v_cvt_pk_bf16_f32 v21, v66, v67
    v_cvt_pk_bf16_f32 v22, v68, v69
    v_cvt_pk_bf16_f32 v23, v70, v71
    v_permlane32_swap_b32 v16, v18
    v_permlane32_swap_b32 v17, v19
    buffer_store_dwordx4 v[16:19], v112, s[36:39], s59 offen offset:64
    v_permlane32_swap_b32 v20, v22
    v_permlane32_swap_b32 v21, v23
    buffer_store_dwordx4 v[20:23], v112, s[36:39], s59 offen offset:96
L_e2_113:
L_end_1:
    s_endpgm
L_fft_2:
    s_sub_u32 s34, s30, 28
    s_lshl_b32 s34, s34, 3
    s_add_u32 s34, s34, s29
    s_cmp_lt_u32 s28, 4
    s_cbranch_scc1 L_nw_120
    s_waitcnt vmcnt(0)
    s_lshr_b32 s58, s2, 2
    s_lshl_b32 s58, s58, 5
    s_and_b32 s101, s2, 3
    s_add_u32 s58, s58, s101
    s_lshl_b32 s58, s58, 2
    s_add_u32 s58, s58, 200704
    v_mov_b32 v8, 141312
    v_mov_b32 v9, 1
    v_mov_b32 v11, s58
    s_mov_b64 exec, 1
    ds_add_rtn_u32 v9, v8, v9 offset:40
    ds_read_b32 v10, v8 offset:28
    s_waitcnt lgkmcnt(0)
    v_readfirstlane_b32 s58, v9
    s_cmp_lg_u32 s58, 3
    s_cbranch_scc1 L_na_121
    buffer_store_dword v10, v11, s[24:27], 0 offen sc1
L_na_121:
    s_mov_b64 exec, -1
L_nw_120:
    s_add_u32 s40, s18, 0x800000
    s_addc_u32 s41, s19, 0
    s_mov_b32 s42, 0x40d080
    s_mov_b32 s43, 0x00020000
    s_add_u32 s44, s18, 0x1000000
    s_addc_u32 s45, s19, 0
    s_mov_b32 s46, 0x412080
    s_mov_b32 s47, 0x00020000
    s_add_u32 s48, s18, 0x2000000
    s_addc_u32 s49, s19, 0
    s_mov_b32 s50, 0x412080
    s_mov_b32 s51, 0x00020000
    v_and_b32 v224, 63, v0
    v_lshlrev_b32 v1, 4, v224
    v_lshrrev_b32 v225, 4, v224
    v_and_b32 v226, 7, v224
    v_xor_b32 v225, v225, v226
    v_lshrrev_b32 v226, 3, v224
    v_lshlrev_b32 v226, 7, v226
    v_lshl_add_u32 v2, v225, 4, v226
    v_xor_b32 v3, 64, v2
    s_lshl_b32 s60, s28, 13
    s_add_u32 s60, s60, 59392
    s_mov_b32 s52, s34
    v_lshlrev_b32 v12, 7, v224
    v_add_u32 v12, 188416, v12
    s_mov_b32 s35, 131072
    s_cmp_lg_u32 s28, 4
    s_cbranch_scc1 L_zi_122
    buffer_load_dwordx4 v[8:11], v12, s[24:27], 0 offen sc1
L_zi_122:
    v_bfe_u32 v225, v224, 1, 3
    v_xor_b32 v225, s28, v225
    v_lshlrev_b32 v225, 4, v225
    v_lshl_add_u32 v225, v224, 7, v225
    v_add_u32 v4, 59392, v225
    v_xor_b32 v5, 0x70, v4
    v_and_b32 v225, 31, v224
    v_lshrrev_b32 v226, 5, v224
    v_lshlrev_b32 v226, 4, v226
    v_lshl_add_u32 v6, v225, 5, v226
    s_mov_b32 s59, 0
    v_and_b32 v225, 31, v224
    v_lshrrev_b32 v226, 5, v224
    v_cvt_f32_u32 v225, v225
    v_cvt_f32_u32 v226, v226
    s_cmp_eq_u32 s28, 1
    s_cbranch_scc1 L_tab1_124
    s_cmp_eq_u32 s28, 2
    s_cbranch_scc1 L_tab2_125
    s_cmp_eq_u32 s28, 3
    s_cbranch_scc1 L_tab3_126
    s_cmp_eq_u32 s28, 4
    s_cbranch_scc1 L_tab4_127
    s_cmp_eq_u32 s28, 5
    s_cbranch_scc1 L_tab5_128
    s_cmp_eq_u32 s28, 6
    s_cbranch_scc1 L_tab6_129
    s_cmp_eq_u32 s28, 7
    s_cbranch_scc1 L_tab7_130
L_tab0_123:
    v_mul_f32 v227, 0x3d000000, v225
    v_mul_f32 v228, 0x40800000, v226
    v_mul_f32 v228, v228, v227
    v_fmamk_f32 v56, v227, 0x00000000, v228
    v_fmamk_f32 v57, v227, 0x3f800000, v228
    v_fmamk_f32 v58, v227, 0x40000000, v228
    v_fmamk_f32 v59, v227, 0x40400000, v228
    v_fmamk_f32 v60, v227, 0x41000000, v228
    v_fmamk_f32 v61, v227, 0x41100000, v228
    v_fmamk_f32 v62, v227, 0x41200000, v228
    v_fmamk_f32 v63, v227, 0x41300000, v228
    v_fmamk_f32 v64, v227, 0x41800000, v228
    v_fmamk_f32 v65, v227, 0x41880000, v228
    v_fmamk_f32 v66, v227, 0x41900000, v228
    v_fmamk_f32 v67, v227, 0x41980000, v228
    v_fmamk_f32 v68, v227, 0x41c00000, v228
    v_fmamk_f32 v69, v227, 0x41c80000, v228
    v_fmamk_f32 v70, v227, 0x41d00000, v228
    v_fmamk_f32 v71, v227, 0x41d80000, v228
    v_cos_f32 v40, v56
    v_sin_f32 v56, v56
    v_cos_f32 v41, v57
    v_sin_f32 v57, v57
    v_cos_f32 v42, v58
    v_sin_f32 v58, v58
    v_cos_f32 v43, v59
    v_sin_f32 v59, v59
    v_cos_f32 v44, v60
    v_sin_f32 v60, v60
    v_cos_f32 v45, v61
    v_sin_f32 v61, v61
    v_cos_f32 v46, v62
    v_sin_f32 v62, v62
    v_cos_f32 v47, v63
    v_sin_f32 v63, v63
    v_cos_f32 v48, v64
    v_sin_f32 v64, v64
    v_cos_f32 v49, v65
    v_sin_f32 v65, v65
    v_cos_f32 v50, v66
    v_sin_f32 v66, v66
    v_cos_f32 v51, v67
    v_sin_f32 v67, v67
    v_cos_f32 v52, v68
    v_sin_f32 v68, v68
    v_cos_f32 v53, v69
    v_sin_f32 v69, v69
    v_cos_f32 v54, v70
    v_sin_f32 v70, v70
    v_cos_f32 v55, v71
    v_sin_f32 v71, v71
    v_cvt_pk_bf16_f32 v160, v40, v41
    v_cvt_pk_bf16_f32 v161, v42, v43
    v_cvt_pk_bf16_f32 v162, v44, v45
    v_cvt_pk_bf16_f32 v163, v46, v47
    v_cvt_pk_bf16_f32 v164, v48, v49
    v_cvt_pk_bf16_f32 v165, v50, v51
    v_cvt_pk_bf16_f32 v166, v52, v53
    v_cvt_pk_bf16_f32 v167, v54, v55
    v_cvt_pk_bf16_f32 v168, v56, v57
    v_cvt_pk_bf16_f32 v169, v58, v59
    v_cvt_pk_bf16_f32 v170, v60, v61
    v_cvt_pk_bf16_f32 v171, v62, v63
    v_cvt_pk_bf16_f32 v172, v64, v65
    v_cvt_pk_bf16_f32 v173, v66, v67
    v_cvt_pk_bf16_f32 v174, v68, v69
    v_cvt_pk_bf16_f32 v175, v70, v71
    v_xor_b32 v176, 0x80008000, v168
    v_xor_b32 v177, 0x80008000, v169
    v_xor_b32 v178, 0x80008000, v170
    v_xor_b32 v179, 0x80008000, v171
    v_xor_b32 v180, 0x80008000, v172
    v_xor_b32 v181, 0x80008000, v173
    v_xor_b32 v182, 0x80008000, v174
    v_xor_b32 v183, 0x80008000, v175
    ds_write_b128 v1, v[160:163] offset:53248
    ds_write_b128 v1, v[164:167] offset:54272
    ds_write_b128 v1, v[168:171] offset:55296
    ds_write_b128 v1, v[172:175] offset:56320
    ds_write_b128 v1, v[176:179] offset:57344
    ds_write_b128 v1, v[180:183] offset:58368
    s_branch L_tabdone_131
L_tab1_124:
    v_mov_b32 v227, 0x3c800000
    v_fmamk_f32 v227, v225, 0x3d000000, v227
    v_mul_f32 v228, 0x40800000, v226
    v_mul_f32 v228, v228, v227
    v_fmamk_f32 v56, v227, 0x00000000, v228
    v_fmamk_f32 v57, v227, 0x3f800000, v228
    v_fmamk_f32 v58, v227, 0x40000000, v228
    v_fmamk_f32 v59, v227, 0x40400000, v228
    v_fmamk_f32 v60, v227, 0x41000000, v228
    v_fmamk_f32 v61, v227, 0x41100000, v228
    v_fmamk_f32 v62, v227, 0x41200000, v228
    v_fmamk_f32 v63, v227, 0x41300000, v228
    v_fmamk_f32 v64, v227, 0x41800000, v228
    v_fmamk_f32 v65, v227, 0x41880000, v228
    v_fmamk_f32 v66, v227, 0x41900000, v228
    v_fmamk_f32 v67, v227, 0x41980000, v228
    v_fmamk_f32 v68, v227, 0x41c00000, v228
    v_fmamk_f32 v69, v227, 0x41c80000, v228
    v_fmamk_f32 v70, v227, 0x41d00000, v228
    v_fmamk_f32 v71, v227, 0x41d80000, v228
    v_cos_f32 v40, v56
    v_sin_f32 v56, v56
    v_cos_f32 v41, v57
    v_sin_f32 v57, v57
    v_cos_f32 v42, v58
    v_sin_f32 v58, v58
    v_cos_f32 v43, v59
    v_sin_f32 v59, v59
    v_cos_f32 v44, v60
    v_sin_f32 v60, v60
    v_cos_f32 v45, v61
    v_sin_f32 v61, v61
    v_cos_f32 v46, v62
    v_sin_f32 v62, v62
    v_cos_f32 v47, v63
    v_sin_f32 v63, v63
    v_cos_f32 v48, v64
    v_sin_f32 v64, v64
    v_cos_f32 v49, v65
    v_sin_f32 v65, v65
    v_cos_f32 v50, v66
    v_sin_f32 v66, v66
    v_cos_f32 v51, v67
    v_sin_f32 v67, v67
    v_cos_f32 v52, v68
    v_sin_f32 v68, v68
    v_cos_f32 v53, v69
    v_sin_f32 v69, v69
    v_cos_f32 v54, v70
    v_sin_f32 v70, v70
    v_cos_f32 v55, v71
    v_sin_f32 v71, v71
    v_cvt_pk_bf16_f32 v160, v40, v41
    v_cvt_pk_bf16_f32 v161, v42, v43
    v_cvt_pk_bf16_f32 v162, v44, v45
    v_cvt_pk_bf16_f32 v163, v46, v47
    v_cvt_pk_bf16_f32 v164, v48, v49
    v_cvt_pk_bf16_f32 v165, v50, v51
    v_cvt_pk_bf16_f32 v166, v52, v53
    v_cvt_pk_bf16_f32 v167, v54, v55
    v_cvt_pk_bf16_f32 v168, v56, v57
    v_cvt_pk_bf16_f32 v169, v58, v59
    v_cvt_pk_bf16_f32 v170, v60, v61
    v_cvt_pk_bf16_f32 v171, v62, v63
    v_cvt_pk_bf16_f32 v172, v64, v65
    v_cvt_pk_bf16_f32 v173, v66, v67
    v_cvt_pk_bf16_f32 v174, v68, v69
    v_cvt_pk_bf16_f32 v175, v70, v71
    v_xor_b32 v176, 0x80008000, v168
    v_xor_b32 v177, 0x80008000, v169
    v_xor_b32 v178, 0x80008000, v170
    v_xor_b32 v179, 0x80008000, v171
    v_xor_b32 v180, 0x80008000, v172
    v_xor_b32 v181, 0x80008000, v173
    v_xor_b32 v182, 0x80008000, v174
    v_xor_b32 v183, 0x80008000, v175
    ds_write_b128 v1, v[160:163] offset:32768
    ds_write_b128 v1, v[164:167] offset:33792
    ds_write_b128 v1, v[168:171] offset:34816
    ds_write_b128 v1, v[172:175] offset:35840
    ds_write_b128 v1, v[176:179] offset:36864
    ds_write_b128 v1, v[180:183] offset:37888
    s_branch L_tabdone_131
L_tab2_125:
    v_mul_f32 v227, 0x3c800000, v225
    v_mul_f32 v228, 0x41000000, v226
    v_add_f32 v228, 0x3f800000, v228
    v_mul_f32 v228, v228, v227
    v_fmamk_f32 v56, v227, 0x00000000, v228
    v_fmamk_f32 v57, v227, 0x40000000, v228
    v_fmamk_f32 v58, v227, 0x40800000, v228
    v_fmamk_f32 v59, v227, 0x40c00000, v228
    v_fmamk_f32 v60, v227, 0x41800000, v228
    v_fmamk_f32 v61, v227, 0x41900000, v228
    v_fmamk_f32 v62, v227, 0x41a00000, v228
    v_fmamk_f32 v63, v227, 0x41b00000, v228
    v_fmamk_f32 v64, v227, 0x42000000, v228
    v_fmamk_f32 v65, v227, 0x42080000, v228
    v_fmamk_f32 v66, v227, 0x42100000, v228
    v_fmamk_f32 v67, v227, 0x42180000, v228
    v_fmamk_f32 v68, v227, 0x42400000, v228
    v_fmamk_f32 v69, v227, 0x42480000, v228
    v_fmamk_f32 v70, v227, 0x42500000, v228
    v_fmamk_f32 v71, v227, 0x42580000, v228
    v_cos_f32 v40, v56
    v_sin_f32 v56, v56
    v_cos_f32 v41, v57
    v_sin_f32 v57, v57
    v_cos_f32 v42, v58
    v_sin_f32 v58, v58
    v_cos_f32 v43, v59
    v_sin_f32 v59, v59
    v_cos_f32 v44, v60
    v_sin_f32 v60, v60
    v_cos_f32 v45, v61
    v_sin_f32 v61, v61
    v_cos_f32 v46, v62
    v_sin_f32 v62, v62
    v_cos_f32 v47, v63
    v_sin_f32 v63, v63
    v_cos_f32 v48, v64
    v_sin_f32 v64, v64
    v_cos_f32 v49, v65
    v_sin_f32 v65, v65
    v_cos_f32 v50, v66
    v_sin_f32 v66, v66
    v_cos_f32 v51, v67
    v_sin_f32 v67, v67
    v_cos_f32 v52, v68
    v_sin_f32 v68, v68
    v_cos_f32 v53, v69
    v_sin_f32 v69, v69
    v_cos_f32 v54, v70
    v_sin_f32 v70, v70
    v_cos_f32 v55, v71
    v_sin_f32 v71, v71
    v_cvt_pk_bf16_f32 v160, v40, v41
    v_cvt_pk_bf16_f32 v161, v42, v43
    v_cvt_pk_bf16_f32 v162, v44, v45
    v_cvt_pk_bf16_f32 v163, v46, v47
    v_cvt_pk_bf16_f32 v164, v48, v49
    v_cvt_pk_bf16_f32 v165, v50, v51
    v_cvt_pk_bf16_f32 v166, v52, v53
    v_cvt_pk_bf16_f32 v167, v54, v55
    v_cvt_pk_bf16_f32 v168, v56, v57
    v_cvt_pk_bf16_f32 v169, v58, v59
    v_cvt_pk_bf16_f32 v170, v60, v61
    v_cvt_pk_bf16_f32 v171, v62, v63
    v_cvt_pk_bf16_f32 v172, v64, v65
    v_cvt_pk_bf16_f32 v173, v66, v67
    v_cvt_pk_bf16_f32 v174, v68, v69
    v_cvt_pk_bf16_f32 v175, v70, v71
    v_xor_b32 v176, 0x80008000, v168
    v_xor_b32 v177, 0x80008000, v169
    v_xor_b32 v178, 0x80008000, v170
    v_xor_b32 v179, 0x80008000, v171
    v_xor_b32 v180, 0x80008000, v172
    v_xor_b32 v181, 0x80008000, v173
    v_xor_b32 v182, 0x80008000, v174
    v_xor_b32 v183, 0x80008000, v175
    ds_write_b128 v1, v[160:163] offset:38912
    ds_write_b128 v1, v[164:167] offset:39936
    ds_write_b128 v1, v[168:171] offset:40960
    ds_write_b128 v1, v[172:175] offset:41984
    ds_write_b128 v1, v[176:179] offset:43008
    ds_write_b128 v1, v[180:183] offset:44032
    s_branch L_tabdone_131
L_tab3_126:
    v_mul_f32 v227, 0x3a000000, v225
    v_mul_f32 v228, 0x40800000, v226
    v_mul_f32 v228, v228, v227
    v_fmamk_f32 v56, v227, 0x00000000, v228
    v_fmamk_f32 v57, v227, 0x3f800000, v228
    v_fmamk_f32 v58, v227, 0x40000000, v228
    v_fmamk_f32 v59, v227, 0x40400000, v228
    v_fmamk_f32 v60, v227, 0x41000000, v228
    v_fmamk_f32 v61, v227, 0x41100000, v228
    v_fmamk_f32 v62, v227, 0x41200000, v228
    v_fmamk_f32 v63, v227, 0x41300000, v228
    v_fmamk_f32 v64, v227, 0x41800000, v228
    v_fmamk_f32 v65, v227, 0x41880000, v228
    v_fmamk_f32 v66, v227, 0x41900000, v228
    v_fmamk_f32 v67, v227, 0x41980000, v228
    v_fmamk_f32 v68, v227, 0x41c00000, v228
    v_fmamk_f32 v69, v227, 0x41c80000, v228
    v_fmamk_f32 v70, v227, 0x41d00000, v228
    v_fmamk_f32 v71, v227, 0x41d80000, v228
    v_cos_f32 v40, v56
    v_sin_f32 v56, v56
    v_cos_f32 v41, v57
    v_sin_f32 v57, v57
    v_cos_f32 v42, v58
    v_sin_f32 v58, v58
    v_cos_f32 v43, v59
    v_sin_f32 v59, v59
    v_cos_f32 v44, v60
    v_sin_f32 v60, v60
    v_cos_f32 v45, v61
    v_sin_f32 v61, v61
    v_cos_f32 v46, v62
    v_sin_f32 v62, v62
    v_cos_f32 v47, v63
    v_sin_f32 v63, v63
    v_cos_f32 v48, v64
    v_sin_f32 v64, v64
    v_cos_f32 v49, v65
    v_sin_f32 v65, v65
    v_cos_f32 v50, v66
    v_sin_f32 v66, v66
    v_cos_f32 v51, v67
    v_sin_f32 v67, v67
    v_cos_f32 v52, v68
    v_sin_f32 v68, v68
    v_cos_f32 v53, v69
    v_sin_f32 v69, v69
    v_cos_f32 v54, v70
    v_sin_f32 v70, v70
    v_cos_f32 v55, v71
    v_sin_f32 v71, v71
    s_nop 0
    ds_write_b128 v1, v[40:43] offset:8192
    ds_write_b128 v1, v[44:47] offset:9216
    ds_write_b128 v1, v[48:51] offset:10240
    ds_write_b128 v1, v[52:55] offset:11264
    ds_write_b128 v1, v[56:59] offset:12288
    ds_write_b128 v1, v[60:63] offset:13312
    ds_write_b128 v1, v[64:67] offset:14336
    ds_write_b128 v1, v[68:71] offset:15360
    s_branch L_tabdone_131
L_tab4_127:
    v_mul_f32 v227, 0x3a000000, v225
    v_mul_f32 v228, 0x40800000, v226
    v_add_f32 v228, 0x42000000, v228
    v_mul_f32 v228, v228, v227
    v_fmamk_f32 v56, v227, 0x00000000, v228
    v_fmamk_f32 v57, v227, 0x3f800000, v228
    v_fmamk_f32 v58, v227, 0x40000000, v228
    v_fmamk_f32 v59, v227, 0x40400000, v228
    v_fmamk_f32 v60, v227, 0x41000000, v228
    v_fmamk_f32 v61, v227, 0x41100000, v228
    v_fmamk_f32 v62, v227, 0x41200000, v228
    v_fmamk_f32 v63, v227, 0x41300000, v228
    v_fmamk_f32 v64, v227, 0x41800000, v228
    v_fmamk_f32 v65, v227, 0x41880000, v228
    v_fmamk_f32 v66, v227, 0x41900000, v228
    v_fmamk_f32 v67, v227, 0x41980000, v228
    v_fmamk_f32 v68, v227, 0x41c00000, v228
    v_fmamk_f32 v69, v227, 0x41c80000, v228
    v_fmamk_f32 v70, v227, 0x41d00000, v228
    v_fmamk_f32 v71, v227, 0x41d80000, v228
    v_cos_f32 v40, v56
    v_sin_f32 v56, v56
    v_cos_f32 v41, v57
    v_sin_f32 v57, v57
    v_cos_f32 v42, v58
    v_sin_f32 v58, v58
    v_cos_f32 v43, v59
    v_sin_f32 v59, v59
    v_cos_f32 v44, v60
    v_sin_f32 v60, v60
    v_cos_f32 v45, v61
    v_sin_f32 v61, v61
    v_cos_f32 v46, v62
    v_sin_f32 v62, v62
    v_cos_f32 v47, v63
    v_sin_f32 v63, v63
    v_cos_f32 v48, v64
    v_sin_f32 v64, v64
    v_cos_f32 v49, v65
    v_sin_f32 v65, v65
    v_cos_f32 v50, v66
    v_sin_f32 v66, v66
    v_cos_f32 v51, v67
    v_sin_f32 v67, v67
    v_cos_f32 v52, v68
    v_sin_f32 v68, v68
    v_cos_f32 v53, v69
    v_sin_f32 v69, v69
    v_cos_f32 v54, v70
    v_sin_f32 v70, v70
    v_cos_f32 v55, v71
    v_sin_f32 v71, v71
    s_nop 0
    ds_write_b128 v1, v[40:43] offset:16384
    ds_write_b128 v1, v[44:47] offset:17408
    ds_write_b128 v1, v[48:51] offset:18432
    ds_write_b128 v1, v[52:55] offset:19456
    ds_write_b128 v1, v[56:59] offset:20480
    ds_write_b128 v1, v[60:63] offset:21504
    ds_write_b128 v1, v[64:67] offset:22528
    ds_write_b128 v1, v[68:71] offset:23552
    s_branch L_tabdone_131
L_tab5_128:
    v_mov_b32 v227, 0x3c800000
    v_fmamk_f32 v227, v225, 0x3a000000, v227
    v_mul_f32 v228, 0x40800000, v226
    v_mul_f32 v228, v228, v227
    v_fmamk_f32 v56, v227, 0x00000000, v228
    v_fmamk_f32 v57, v227, 0x3f800000, v228
    v_fmamk_f32 v58, v227, 0x40000000, v228
    v_fmamk_f32 v59, v227, 0x40400000, v228
    v_fmamk_f32 v60, v227, 0x41000000, v228
    v_fmamk_f32 v61, v227, 0x41100000, v228
    v_fmamk_f32 v62, v227, 0x41200000, v228
    v_fmamk_f32 v63, v227, 0x41300000, v228
    v_fmamk_f32 v64, v227, 0x41800000, v228
    v_fmamk_f32 v65, v227, 0x41880000, v228
    v_fmamk_f32 v66, v227, 0x41900000, v228
    v_fmamk_f32 v67, v227, 0x41980000, v228
    v_fmamk_f32 v68, v227, 0x41c00000, v228
    v_fmamk_f32 v69, v227, 0x41c80000, v228
    v_fmamk_f32 v70, v227, 0x41d00000, v228
    v_fmamk_f32 v71, v227, 0x41d80000, v228
    v_cos_f32 v40, v56
    v_sin_f32 v56, v56
    v_cos_f32 v41, v57
    v_sin_f32 v57, v57
    v_cos_f32 v42, v58
    v_sin_f32 v58, v58
    v_cos_f32 v43, v59
    v_sin_f32 v59, v59
    v_cos_f32 v44, v60
    v_sin_f32 v60, v60
    v_cos_f32 v45, v61
    v_sin_f32 v61, v61
    v_cos_f32 v46, v62
    v_sin_f32 v62, v62
    v_cos_f32 v47, v63
    v_sin_f32 v63, v63
    v_cos_f32 v48, v64
    v_sin_f32 v64, v64
    v_cos_f32 v49, v65
    v_sin_f32 v65, v65
    v_cos_f32 v50, v66
    v_sin_f32 v66, v66
    v_cos_f32 v51, v67
    v_sin_f32 v67, v67
    v_cos_f32 v52, v68
    v_sin_f32 v68, v68
    v_cos_f32 v53, v69
    v_sin_f32 v69, v69
    v_cos_f32 v54, v70
    v_sin_f32 v70, v70
    v_cos_f32 v55, v71
    v_sin_f32 v71, v71
    s_nop 0
    ds_write_b128 v1, v[40:43] offset:24576
    ds_write_b128 v1, v[44:47] offset:25600
    ds_write_b128 v1, v[48:51] offset:26624
    ds_write_b128 v1, v[52:55] offset:27648
    ds_write_b128 v1, v[56:59] offset:28672
    ds_write_b128 v1, v[60:63] offset:29696
    ds_write_b128 v1, v[64:67] offset:30720
    ds_write_b128 v1, v[68:71] offset:31744
    s_branch L_tabdone_131
L_tab6_129:
    v_mul_f32 v227, 0x3d000000, v225
    v_mul_f32 v228, 0x40800000, v226
    v_mul_f32 v228, v228, v227
    v_fmamk_f32 v56, v227, 0x00000000, v228
    v_fmamk_f32 v57, v227, 0x3f800000, v228
    v_fmamk_f32 v58, v227, 0x40000000, v228
    v_fmamk_f32 v59, v227, 0x40400000, v228
    v_fmamk_f32 v60, v227, 0x41000000, v228
    v_fmamk_f32 v61, v227, 0x41100000, v228
    v_fmamk_f32 v62, v227, 0x41200000, v228
    v_fmamk_f32 v63, v227, 0x41300000, v228
    v_lshlrev_b32 v227, 31, v224
    v_xor_b32 v227, 0x3e000000, v227
    v_sub_f32 v64, v56, v227
    v_add_f32 v56, v56, v227
    v_sub_f32 v65, v57, v227
    v_add_f32 v57, v57, v227
    v_sub_f32 v66, v58, v227
    v_add_f32 v58, v58, v227
    v_sub_f32 v67, v59, v227
    v_add_f32 v59, v59, v227
    v_sub_f32 v68, v60, v227
    v_add_f32 v60, v60, v227
    v_sub_f32 v69, v61, v227
    v_add_f32 v61, v61, v227
    v_sub_f32 v70, v62, v227
    v_add_f32 v62, v62, v227
    v_sub_f32 v71, v63, v227
    v_add_f32 v63, v63, v227
    v_cos_f32 v40, v56
    v_sin_f32 v56, v56
    v_cos_f32 v41, v57
    v_sin_f32 v57, v57
    v_cos_f32 v42, v58
    v_sin_f32 v58, v58
    v_cos_f32 v43, v59
    v_sin_f32 v59, v59
    v_cos_f32 v44, v60
    v_sin_f32 v60, v60
    v_cos_f32 v45, v61
    v_sin_f32 v61, v61
    v_cos_f32 v46, v62
    v_sin_f32 v62, v62
    v_cos_f32 v47, v63
    v_sin_f32 v63, v63
    v_cos_f32 v48, v64
    v_sin_f32 v64, v64
    v_cos_f32 v49, v65
    v_sin_f32 v65, v65
    v_cos_f32 v50, v66
    v_sin_f32 v66, v66
    v_cos_f32 v51, v67
    v_sin_f32 v67, v67
    v_cos_f32 v52, v68
    v_sin_f32 v68, v68
    v_cos_f32 v53, v69
    v_sin_f32 v69, v69
    v_cos_f32 v54, v70
    v_sin_f32 v70, v70
    v_cos_f32 v55, v71
    v_sin_f32 v71, v71
    v_cvt_pk_bf16_f32 v160, v40, v56
    v_cvt_pk_bf16_f32 v168, v48, -v64
    v_cvt_pk_bf16_f32 v176, -v56, v40
    v_cvt_pk_bf16_f32 v184, -v64, -v48
    v_cvt_pk_bf16_f32 v161, v41, v57
    v_cvt_pk_bf16_f32 v169, v49, -v65
    v_cvt_pk_bf16_f32 v177, -v57, v41
    v_cvt_pk_bf16_f32 v185, -v65, -v49
    v_cvt_pk_bf16_f32 v162, v42, v58
    v_cvt_pk_bf16_f32 v170, v50, -v66
    v_cvt_pk_bf16_f32 v178, -v58, v42
    v_cvt_pk_bf16_f32 v186, -v66, -v50
    v_cvt_pk_bf16_f32 v163, v43, v59
    v_cvt_pk_bf16_f32 v171, v51, -v67
    v_cvt_pk_bf16_f32 v179, -v59, v43
    v_cvt_pk_bf16_f32 v187, -v67, -v51
    v_cvt_pk_bf16_f32 v164, v44, v60
    v_cvt_pk_bf16_f32 v172, v52, -v68
    v_cvt_pk_bf16_f32 v180, -v60, v44
    v_cvt_pk_bf16_f32 v188, -v68, -v52
    v_cvt_pk_bf16_f32 v165, v45, v61
    v_cvt_pk_bf16_f32 v173, v53, -v69
    v_cvt_pk_bf16_f32 v181, -v61, v45
    v_cvt_pk_bf16_f32 v189, -v69, -v53
    v_cvt_pk_bf16_f32 v166, v46, v62
    v_cvt_pk_bf16_f32 v174, v54, -v70
    v_cvt_pk_bf16_f32 v182, -v62, v46
    v_cvt_pk_bf16_f32 v190, -v70, -v54
    v_cvt_pk_bf16_f32 v167, v47, v63
    v_cvt_pk_bf16_f32 v175, v55, -v71
    v_cvt_pk_bf16_f32 v183, -v63, v47
    v_cvt_pk_bf16_f32 v191, -v71, -v55
    ds_write_b128 v1, v[160:163] offset:0
    ds_write_b128 v1, v[164:167] offset:1024
    ds_write_b128 v1, v[168:171] offset:2048
    ds_write_b128 v1, v[172:175] offset:3072
    ds_write_b128 v1, v[176:179] offset:4096
    ds_write_b128 v1, v[180:183] offset:5120
    ds_write_b128 v1, v[184:187] offset:6144
    ds_write_b128 v1, v[188:191] offset:7168
    s_branch L_tabdone_131
L_tab7_130:
    v_and_b32 v225, 15, v224
    v_cvt_f32_u32 v225, v225
    v_lshlrev_b32 v224, 27, v224
    v_and_b32 v224, 0x80000000, v224
    v_xor_b32 v225, v224, v225
    v_mul_f32 v227, 0x3d000000, v225
    v_mul_f32 v228, 0x40800000, v226
    v_mul_f32 v228, v228, v227
    v_fmamk_f32 v56, v227, 0x00000000, v228
    v_fmamk_f32 v57, v227, 0x3f800000, v228
    v_fmamk_f32 v58, v227, 0x40000000, v228
    v_fmamk_f32 v59, v227, 0x40400000, v228
    v_fmamk_f32 v60, v227, 0x41000000, v228
    v_fmamk_f32 v61, v227, 0x41100000, v228
    v_fmamk_f32 v62, v227, 0x41200000, v228
    v_fmamk_f32 v63, v227, 0x41300000, v228
    v_fmamk_f32 v64, v227, 0x41800000, v228
    v_fmamk_f32 v65, v227, 0x41880000, v228
    v_fmamk_f32 v66, v227, 0x41900000, v228
    v_fmamk_f32 v67, v227, 0x41980000, v228
    v_fmamk_f32 v68, v227, 0x41c00000, v228
    v_fmamk_f32 v69, v227, 0x41c80000, v228
    v_fmamk_f32 v70, v227, 0x41d00000, v228
    v_fmamk_f32 v71, v227, 0x41d80000, v228
    v_add_f32 v56, 0x3e000000, v56
    v_add_f32 v57, 0xbe000000, v57
    v_add_f32 v58, 0x3e000000, v58
    v_add_f32 v59, 0xbe000000, v59
    v_add_f32 v60, 0x3e000000, v60
    v_add_f32 v61, 0xbe000000, v61
    v_add_f32 v62, 0x3e000000, v62
    v_add_f32 v63, 0xbe000000, v63
    v_add_f32 v64, 0x3e000000, v64
    v_add_f32 v65, 0xbe000000, v65
    v_add_f32 v66, 0x3e000000, v66
    v_add_f32 v67, 0xbe000000, v67
    v_add_f32 v68, 0x3e000000, v68
    v_add_f32 v69, 0xbe000000, v69
    v_add_f32 v70, 0x3e000000, v70
    v_add_f32 v71, 0xbe000000, v71
    v_cos_f32 v40, v56
    v_sin_f32 v56, v56
    v_cos_f32 v41, v57
    v_sin_f32 v57, v57
    v_cos_f32 v42, v58
    v_sin_f32 v58, v58
    v_cos_f32 v43, v59
    v_sin_f32 v59, v59
    v_cos_f32 v44, v60
    v_sin_f32 v60, v60
    v_cos_f32 v45, v61
    v_sin_f32 v61, v61
    v_cos_f32 v46, v62
    v_sin_f32 v62, v62
    v_cos_f32 v47, v63
    v_sin_f32 v63, v63
    v_cos_f32 v48, v64
    v_sin_f32 v64, v64
    v_cos_f32 v49, v65
    v_sin_f32 v65, v65
    v_cos_f32 v50, v66
    v_sin_f32 v66, v66
    v_cos_f32 v51, v67
    v_sin_f32 v67, v67
    v_cos_f32 v52, v68
    v_sin_f32 v68, v68
    v_cos_f32 v53, v69
    v_sin_f32 v69, v69
    v_cos_f32 v54, v70
    v_sin_f32 v70, v70
    v_cos_f32 v55, v71
    v_sin_f32 v71, v71
    v_lshrrev_b32 v227, 16, v224
    v_or_b32 v227, v227, v224
    v_xor_b32 v228, 0x80008000, v227
    v_cvt_pk_bf16_f32 v160, v40, v41
    v_cvt_pk_bf16_f32 v161, v42, v43
    v_cvt_pk_bf16_f32 v162, v44, v45
    v_cvt_pk_bf16_f32 v163, v46, v47
    v_cvt_pk_bf16_f32 v164, v48, v49
    v_cvt_pk_bf16_f32 v165, v50, v51
    v_cvt_pk_bf16_f32 v166, v52, v53
    v_cvt_pk_bf16_f32 v167, v54, v55
    v_cvt_pk_bf16_f32 v176, v56, v57
    v_cvt_pk_bf16_f32 v177, v58, v59
    v_cvt_pk_bf16_f32 v178, v60, v61
    v_cvt_pk_bf16_f32 v179, v62, v63
    v_cvt_pk_bf16_f32 v180, v64, v65
    v_cvt_pk_bf16_f32 v181, v66, v67
    v_cvt_pk_bf16_f32 v182, v68, v69
    v_cvt_pk_bf16_f32 v183, v70, v71
    v_xor_b32 v168, v228, v176
    v_xor_b32 v184, v227, v160
    v_xor_b32 v169, v228, v177
    v_xor_b32 v185, v227, v161
    v_xor_b32 v170, v228, v178
    v_xor_b32 v186, v227, v162
    v_xor_b32 v171, v228, v179
    v_xor_b32 v187, v227, v163
    v_xor_b32 v172, v228, v180
    v_xor_b32 v188, v227, v164
    v_xor_b32 v173, v228, v181
    v_xor_b32 v189, v227, v165
    v_xor_b32 v174, v228, v182
    v_xor_b32 v190, v227, v166
    v_xor_b32 v175, v228, v183
    v_xor_b32 v191, v227, v167
    ds_write_b128 v1, v[160:163] offset:45056
    ds_write_b128 v1, v[164:167] offset:46080
    ds_write_b128 v1, v[168:171] offset:47104
    ds_write_b128 v1, v[172:175] offset:48128
    ds_write_b128 v1, v[176:179] offset:49152
    ds_write_b128 v1, v[180:183] offset:50176
    ds_write_b128 v1, v[184:187] offset:51200
    ds_write_b128 v1, v[188:191] offset:52224
L_tabdone_131:
    s_cmp_lg_u32 s28, 4
    s_cbranch_scc1 L_zw_132
L_zr_133:
    s_waitcnt vmcnt(0)
    v_xor_b32 v8, s31, v8
    v_xor_b32 v9, s31, v9
    v_xor_b32 v10, s31, v10
    v_xor_b32 v11, s31, v11
    v_or3_b32 v8, v8, v9, v10
    v_or_b32 v8, v8, v11
    v_cmp_eq_u32 s[36:37], 0, v8
    s_cmp_eq_u64 s[36:37], -1
    s_cbranch_scc1 L_zw_132
    s_sub_u32 s35, s35, 1
    s_cbranch_scc1 L_zw_132
    s_sleep 2
    buffer_load_dwordx4 v[8:11], v12, s[24:27], 0 offen sc1
    s_branch L_zr_133
L_zw_132:
    s_waitcnt vmcnt(0)
    s_barrier
    s_sub_u32 s56, 128, s52
    s_cmp_lt_u32 s28, 4
    s_cselect_b32 s56, s52, s56
    s_mul_i32 s54, s56, 32896
    s_and_b32 s56, s28, 3
    s_lshl_b32 s56, s56, 13
    s_add_u32 s54, s54, s56
    s_add_u32 s55, s54, 4096
    s_add_u32 m0, s60, 0
    s_nop 0
    buffer_load_dwordx4 v2, s[40:43], s54 offen offset:0 lds
    s_add_u32 m0, s60, 0
    s_nop 0
    buffer_load_dwordx4 v3, s[40:43], s54 offen offset:1024 lds
    s_add_u32 m0, s60, 0
    s_nop 0
    buffer_load_dwordx4 v2, s[40:43], s54 offen offset:2048 lds
    s_add_u32 m0, s60, 0
    s_nop 0
    buffer_load_dwordx4 v3, s[40:43], s54 offen offset:3072 lds
    s_add_u32 m0, s60, 4096
    s_nop 0
    buffer_load_dwordx4 v2, s[40:43], s55 offen offset:0 lds
    s_add_u32 m0, s60, 4096
    s_nop 0
    buffer_load_dwordx4 v3, s[40:43], s55 offen offset:1024 lds
    s_add_u32 m0, s60, 4096
    s_nop 0
    buffer_load_dwordx4 v2, s[40:43], s55 offen offset:2048 lds
    s_add_u32 m0, s60, 4096
    s_nop 0
    buffer_load_dwordx4 v3, s[40:43], s55 offen offset:3072 lds
    v_lshlrev_b32 v108, 3, v1
    v_add_u32 v108, 200704, v108
    s_cmp_lg_u32 s28, 4
    s_cbranch_scc1 L_wi_134
    buffer_load_dwordx4 v[104:107], v108, s[24:27], 0 offen sc1
L_wi_134:
    ds_read_b128 v[136:139], v1 offset:53248
    ds_read_b128 v[140:143], v1 offset:54272
    ds_read_b128 v[144:147], v1 offset:55296
    ds_read_b128 v[148:151], v1 offset:56320
    ds_read_b128 v[152:155], v1 offset:57344
    ds_read_b128 v[156:159], v1 offset:58368
    s_waitcnt lgkmcnt(0)
    ds_read_b128 v[160:163], v1 offset:0
    ds_read_b128 v[164:167], v1 offset:1024
    ds_read_b128 v[168:171], v1 offset:2048
    ds_read_b128 v[172:175], v1 offset:3072
    ds_read_b128 v[176:179], v1 offset:4096
    ds_read_b128 v[180:183], v1 offset:5120
    ds_read_b128 v[184:187], v1 offset:6144
    ds_read_b128 v[188:191], v1 offset:7168
    s_waitcnt lgkmcnt(0)
    ds_read_b128 v[192:195], v1 offset:8192
    ds_read_b128 v[196:199], v1 offset:9216
    ds_read_b128 v[200:203], v1 offset:10240
    ds_read_b128 v[204:207], v1 offset:11264
    ds_read_b128 v[208:211], v1 offset:12288
    ds_read_b128 v[212:215], v1 offset:13312
    ds_read_b128 v[216:219], v1 offset:14336
    ds_read_b128 v[220:223], v1 offset:15360
    s_waitcnt lgkmcnt(0)
    ds_read_b128 v[224:227], v1 offset:16384
    ds_read_b128 v[228:231], v1 offset:17408
    ds_read_b128 v[232:235], v1 offset:18432
    ds_read_b128 v[236:239], v1 offset:19456
    ds_read_b128 v[240:243], v1 offset:20480
    ds_read_b128 v[244:247], v1 offset:21504
    ds_read_b128 v[248:251], v1 offset:22528
    ds_read_b128 v[252:255], v1 offset:23552
    s_waitcnt vmcnt(0) lgkmcnt(0)
    s_barrier
    ds_read_b128 v[8:11], v4 offset:0
    ds_read_b128 v[24:27], v5 offset:32768
    ds_read_b128 v[12:15], v4 offset:8192
    ds_read_b128 v[28:31], v5 offset:40960
    ds_read_b128 v[16:19], v4 offset:16384
    ds_read_b128 v[32:35], v5 offset:49152
    ds_read_b128 v[20:23], v4 offset:24576
    ds_read_b128 v[36:39], v5 offset:57344
    s_waitcnt lgkmcnt(0)
    s_cmp_lg_u32 s28, 4
    s_cbranch_scc1 L_zw_135
L_zr_136:
    s_waitcnt vmcnt(0)
    v_xor_b32 v104, s31, v104
    v_xor_b32 v105, s31, v105
    v_xor_b32 v106, s31, v106
    v_xor_b32 v107, s31, v107
    v_or3_b32 v104, v104, v105, v106
    v_or_b32 v104, v104, v107
    v_cmp_eq_u32 s[36:37], 0, v104
    s_cmp_eq_u64 s[36:37], -1
    s_cbranch_scc1 L_zw_135
    s_sub_u32 s35, s35, 1
    s_cbranch_scc1 L_zw_135
    s_sleep 2
    buffer_load_dwordx4 v[104:107], v108, s[24:27], 0 offen sc1
    s_branch L_zr_136
L_zw_135:
    s_barrier
    s_mul_i32 s54, s52, 65664
    s_lshl_b32 s56, s28, 13
    s_add_u32 s54, s54, s56
    s_add_u32 s55, s54, 4096
    s_add_u32 m0, s60, 0
    s_nop 0
    buffer_load_dwordx4 v2, s[44:47], s54 offen offset:0 lds
    s_add_u32 m0, s60, 0
    s_nop 0
    buffer_load_dwordx4 v3, s[44:47], s54 offen offset:1024 lds
    s_add_u32 m0, s60, 0
    s_nop 0
    buffer_load_dwordx4 v2, s[44:47], s54 offen offset:2048 lds
    s_add_u32 m0, s60, 0
    s_nop 0
    buffer_load_dwordx4 v3, s[44:47], s54 offen offset:3072 lds
    s_add_u32 m0, s60, 4096
    s_nop 0
    buffer_load_dwordx4 v2, s[44:47], s55 offen offset:0 lds
    s_add_u32 m0, s60, 4096
    s_nop 0
    buffer_load_dwordx4 v3, s[44:47], s55 offen offset:1024 lds
    s_add_u32 m0, s60, 4096
    s_nop 0
    buffer_load_dwordx4 v2, s[44:47], s55 offen offset:2048 lds
    s_add_u32 m0, s60, 4096
    s_nop 0
    buffer_load_dwordx4 v3, s[44:47], s55 offen offset:3072 lds
L_t2top_137:
    s_lshl_b32 s53, s52, 3
    s_add_u32 s53, s53, s28
    s_mul_i32 s57, s53, 8320
    s_add_u32 s58, s57, 4096
    s_add_u32 s52, s52, 32
    s_waitcnt lgkmcnt(15)
    v_mfma_f32_32x32x16_bf16 v[40:55], v[8:11], v[160:163], 0
    v_mfma_f32_32x32x16_bf16 v[56:71], v[8:11], v[176:179], 0
    v_mfma_f32_32x32x16_bf16 v[40:55], v[12:15], v[164:167], v[40:55]
    v_mfma_f32_32x32x16_bf16 v[56:71], v[12:15], v[180:183], v[56:71]
    v_mfma_f32_32x32x16_bf16 v[40:55], v[24:27], v[168:171], v[40:55]
    v_mfma_f32_32x32x16_bf16 v[56:71], v[24:27], v[184:187], v[56:71]
    v_mfma_f32_32x32x16_bf16 v[40:55], v[28:31], v[172:175], v[40:55]
    v_mfma_f32_32x32x16_bf16 v[56:71], v[28:31], v[188:191], v[56:71]
    s_waitcnt lgkmcnt(0)
    v_mfma_f32_32x32x16_bf16 v[72:87], v[16:19], v[160:163], 0
    v_mfma_f32_32x32x16_bf16 v[88:103], v[16:19], v[176:179], 0
    s_nop 7
    v_pk_mul_f32 v[104:105], v[40:41], v[208:209]
    v_pk_mul_f32 v[106:107], v[42:43], v[210:211]
    v_pk_mul_f32 v[108:109], v[44:45], v[212:213]
    v_pk_mul_f32 v[110:111], v[46:47], v[214:215]
    v_pk_mul_f32 v[112:113], v[48:49], v[216:217]
    v_mfma_f32_32x32x16_bf16 v[72:87], v[20:23], v[164:167], v[72:87]
    v_pk_mul_f32 v[114:115], v[50:51], v[218:219]
    v_pk_mul_f32 v[116:117], v[52:53], v[220:221]
    v_pk_mul_f32 v[118:119], v[54:55], v[222:223]
    v_pk_mul_f32 v[40:41], v[40:41], v[192:193]
    v_pk_mul_f32 v[42:43], v[42:43], v[194:195]
    v_mfma_f32_32x32x16_bf16 v[88:103], v[20:23], v[180:183], v[88:103]
    v_pk_mul_f32 v[44:45], v[44:45], v[196:197]
    v_pk_mul_f32 v[46:47], v[46:47], v[198:199]
    v_pk_mul_f32 v[48:49], v[48:49], v[200:201]
    v_pk_mul_f32 v[50:51], v[50:51], v[202:203]
    v_mfma_f32_32x32x16_bf16 v[72:87], v[32:35], v[168:171], v[72:87]
    v_pk_mul_f32 v[52:53], v[52:53], v[204:205]
    v_pk_mul_f32 v[54:55], v[54:55], v[206:207]
    v_pk_fma_f32 v[40:41], v[56:57], v[208:209], v[40:41]
    v_pk_fma_f32 v[42:43], v[58:59], v[210:211], v[42:43]
    v_pk_fma_f32 v[44:45], v[60:61], v[212:213], v[44:45]
    v_mfma_f32_32x32x16_bf16 v[88:103], v[32:35], v[184:187], v[88:103]
    v_pk_fma_f32 v[46:47], v[62:63], v[214:215], v[46:47]
    v_pk_fma_f32 v[48:49], v[64:65], v[216:217], v[48:49]
    v_pk_fma_f32 v[50:51], v[66:67], v[218:219], v[50:51]
    v_pk_fma_f32 v[52:53], v[68:69], v[220:221], v[52:53]
    v_mfma_f32_32x32x16_bf16 v[72:87], v[36:39], v[172:175], v[72:87]
    v_pk_fma_f32 v[54:55], v[70:71], v[222:223], v[54:55]
    v_pk_fma_f32 v[56:57], v[56:57], v[192:193], v[104:105] neg_lo:[0,0,1] neg_hi:[0,0,1]
    v_pk_fma_f32 v[58:59], v[58:59], v[194:195], v[106:107] neg_lo:[0,0,1] neg_hi:[0,0,1]
    v_pk_fma_f32 v[60:61], v[60:61], v[196:197], v[108:109] neg_lo:[0,0,1] neg_hi:[0,0,1]
    v_pk_fma_f32 v[62:63], v[62:63], v[198:199], v[110:111] neg_lo:[0,0,1] neg_hi:[0,0,1]
    v_mfma_f32_32x32x16_bf16 v[88:103], v[36:39], v[188:191], v[88:103]
    v_pk_fma_f32 v[64:65], v[64:65], v[200:201], v[112:113] neg_lo:[0,0,1] neg_hi:[0,0,1]
    v_pk_fma_f32 v[66:67], v[66:67], v[202:203], v[114:115] neg_lo:[0,0,1] neg_hi:[0,0,1]
    v_pk_fma_f32 v[68:69], v[68:69], v[204:205], v[116:117] neg_lo:[0,0,1] neg_hi:[0,0,1]
    v_pk_fma_f32 v[70:71], v[70:71], v[206:207], v[118:119] neg_lo:[0,0,1] neg_hi:[0,0,1]
    ds_read_b128 v[192:195], v1 offset:32768
    ds_read_b128 v[196:199], v1 offset:33792
    ds_read_b128 v[200:203], v1 offset:34816
    ds_read_b128 v[204:207], v1 offset:35840
    ds_read_b128 v[208:211], v1 offset:36864
    ds_read_b128 v[212:215], v1 offset:37888
    v_pk_fma_f32 v[120:121], v[72:73], v[224:225], v[40:41]
    v_pk_fma_f32 v[122:123], v[74:75], v[226:227], v[42:43]
    v_pk_fma_f32 v[124:125], v[76:77], v[228:229], v[44:45]
    v_pk_fma_f32 v[126:127], v[78:79], v[230:231], v[46:47]
    v_pk_fma_f32 v[128:129], v[80:81], v[232:233], v[48:49]
    v_pk_fma_f32 v[130:131], v[82:83], v[234:235], v[50:51]
    v_pk_fma_f32 v[132:133], v[84:85], v[236:237], v[52:53]
    v_pk_fma_f32 v[134:135], v[86:87], v[238:239], v[54:55]
    v_pk_fma_f32 v[72:73], v[72:73], v[240:241], v[56:57] neg_lo:[0,1,0] neg_hi:[0,1,0]
    v_pk_fma_f32 v[74:75], v[74:75], v[242:243], v[58:59] neg_lo:[0,1,0] neg_hi:[0,1,0]
    v_pk_fma_f32 v[76:77], v[76:77], v[244:245], v[60:61] neg_lo:[0,1,0] neg_hi:[0,1,0]
    v_pk_fma_f32 v[78:79], v[78:79], v[246:247], v[62:63] neg_lo:[0,1,0] neg_hi:[0,1,0]
    v_pk_fma_f32 v[80:81], v[80:81], v[248:249], v[64:65] neg_lo:[0,1,0] neg_hi:[0,1,0]
    v_pk_fma_f32 v[82:83], v[82:83], v[250:251], v[66:67] neg_lo:[0,1,0] neg_hi:[0,1,0]
    v_pk_fma_f32 v[84:85], v[84:85], v[252:253], v[68:69] neg_lo:[0,1,0] neg_hi:[0,1,0]
    v_pk_fma_f32 v[86:87], v[86:87], v[254:255], v[70:71] neg_lo:[0,1,0] neg_hi:[0,1,0]
    v_pk_fma_f32 v[72:73], v[88:89], v[224:225], v[72:73]
    v_pk_fma_f32 v[74:75], v[90:91], v[226:227], v[74:75]
    v_pk_fma_f32 v[76:77], v[92:93], v[228:229], v[76:77]
    v_pk_fma_f32 v[78:79], v[94:95], v[230:231], v[78:79]
    v_pk_fma_f32 v[80:81], v[96:97], v[232:233], v[80:81]
    v_pk_fma_f32 v[82:83], v[98:99], v[234:235], v[82:83]
    v_pk_fma_f32 v[84:85], v[100:101], v[236:237], v[84:85]
    v_pk_fma_f32 v[86:87], v[102:103], v[238:239], v[86:87]
    v_pk_fma_f32 v[88:89], v[88:89], v[240:241], v[120:121]
    v_pk_fma_f32 v[90:91], v[90:91], v[242:243], v[122:123]
    v_pk_fma_f32 v[92:93], v[92:93], v[244:245], v[124:125]
    v_pk_fma_f32 v[94:95], v[94:95], v[246:247], v[126:127]
    v_pk_fma_f32 v[96:97], v[96:97], v[248:249], v[128:129]
    v_pk_fma_f32 v[98:99], v[98:99], v[250:251], v[130:131]
    v_pk_fma_f32 v[100:101], v[100:101], v[252:253], v[132:133]
    v_pk_fma_f32 v[102:103], v[102:103], v[254:255], v[134:135]
    v_pk_fma_f32 v[40:41], v[40:41], 2.0, v[88:89] op_sel_hi:[1,0,1] neg_lo:[0,0,1] neg_hi:[0,0,1]
    v_pk_fma_f32 v[42:43], v[42:43], 2.0, v[90:91] op_sel_hi:[1,0,1] neg_lo:[0,0,1] neg_hi:[0,0,1]
    v_pk_fma_f32 v[44:45], v[44:45], 2.0, v[92:93] op_sel_hi:[1,0,1] neg_lo:[0,0,1] neg_hi:[0,0,1]
    v_pk_fma_f32 v[46:47], v[46:47], 2.0, v[94:95] op_sel_hi:[1,0,1] neg_lo:[0,0,1] neg_hi:[0,0,1]
    v_pk_fma_f32 v[48:49], v[48:49], 2.0, v[96:97] op_sel_hi:[1,0,1] neg_lo:[0,0,1] neg_hi:[0,0,1]
    v_pk_fma_f32 v[50:51], v[50:51], 2.0, v[98:99] op_sel_hi:[1,0,1] neg_lo:[0,0,1] neg_hi:[0,0,1]
    v_pk_fma_f32 v[52:53], v[52:53], 2.0, v[100:101] op_sel_hi:[1,0,1] neg_lo:[0,0,1] neg_hi:[0,0,1]
    v_pk_fma_f32 v[54:55], v[54:55], 2.0, v[102:103] op_sel_hi:[1,0,1] neg_lo:[0,0,1] neg_hi:[0,0,1]
    v_pk_fma_f32 v[56:57], v[56:57], 2.0, v[72:73] op_sel_hi:[1,0,1] neg_lo:[0,0,1] neg_hi:[0,0,1]
    v_pk_fma_f32 v[58:59], v[58:59], 2.0, v[74:75] op_sel_hi:[1,0,1] neg_lo:[0,0,1] neg_hi:[0,0,1]
    v_pk_fma_f32 v[60:61], v[60:61], 2.0, v[76:77] op_sel_hi:[1,0,1] neg_lo:[0,0,1] neg_hi:[0,0,1]
    v_pk_fma_f32 v[62:63], v[62:63], 2.0, v[78:79] op_sel_hi:[1,0,1] neg_lo:[0,0,1] neg_hi:[0,0,1]
    v_pk_fma_f32 v[64:65], v[64:65], 2.0, v[80:81] op_sel_hi:[1,0,1] neg_lo:[0,0,1] neg_hi:[0,0,1]
    v_pk_fma_f32 v[66:67], v[66:67], 2.0, v[82:83] op_sel_hi:[1,0,1] neg_lo:[0,0,1] neg_hi:[0,0,1]
    v_pk_fma_f32 v[68:69], v[68:69], 2.0, v[84:85] op_sel_hi:[1,0,1] neg_lo:[0,0,1] neg_hi:[0,0,1]
    v_pk_fma_f32 v[70:71], v[70:71], 2.0, v[86:87] op_sel_hi:[1,0,1] neg_lo:[0,0,1] neg_hi:[0,0,1]
    v_cvt_pk_bf16_f32 v104, v88, v89
    v_cvt_pk_bf16_f32 v105, v90, v91
    v_cvt_pk_bf16_f32 v106, v92, v93
    v_cvt_pk_bf16_f32 v107, v94, v95
    v_cvt_pk_bf16_f32 v108, v96, v97
    v_cvt_pk_bf16_f32 v109, v98, v99
    v_cvt_pk_bf16_f32 v110, v100, v101
    v_cvt_pk_bf16_f32 v111, v102, v103
    v_cvt_pk_bf16_f32 v112, v72, v73
    v_cvt_pk_bf16_f32 v113, v74, v75
    v_cvt_pk_bf16_f32 v114, v76, v77
    v_cvt_pk_bf16_f32 v115, v78, v79
    v_cvt_pk_bf16_f32 v116, v80, v81
    v_cvt_pk_bf16_f32 v117, v82, v83
    v_cvt_pk_bf16_f32 v118, v84, v85
    v_cvt_pk_bf16_f32 v119, v86, v87
    s_cmp_lg_u32 s59, 0
    s_cbranch_scc1 L_w1_138
    s_waitcnt vmcnt(6) lgkmcnt(0)
    s_cmp_ge_u32 s52, 64
    s_cbranch_scc1 L_first_142
    s_and_b32 s56, s28, 3
    s_lshl_b32 s56, s56, 10
    s_cmp_lt_u32 s28, 4
    s_cselect_b32 s48, s40, s44
    s_cselect_b32 s49, s41, s45
    s_cselect_b32 s50, s42, s46
    s_mov_b32 s54, 4202496
    s_cmov_b32 s54, 4243584
    s_cselect_b32 s55, 0, 4096
    s_mov_b32 s61, 133120
    s_cmov_b32 s61, 124928
    s_add_u32 s54, s54, s56
    s_add_u32 s55, s55, s54
    s_add_u32 s61, s61, s56
    s_cmp_eq_u32 s34, 0
    s_cselect_b32 s50, s50, 0
    s_mov_b32 m0, s61
    s_add_u32 s61, s61, 4096
    buffer_load_dwordx4 v1, s[48:51], s54 offen lds
    s_mov_b32 m0, s61
    s_nop 0
    buffer_load_dwordx4 v1, s[48:51], s55 offen lds
    s_add_u32 s48, s18, 0x2000000
    s_addc_u32 s49, s19, 0
    s_mov_b32 s50, 0x412080
    s_mov_b32 s51, 0x00020000
    s_waitcnt vmcnt(2)
L_first_142:
    s_barrier
    ds_read_b128 v[8:11], v4 offset:0
    ds_read_b128 v[12:15], v4 offset:8192
    ds_read_b128 v[16:19], v4 offset:16384
    ds_read_b128 v[20:23], v4 offset:24576
    ds_read_b128 v[24:27], v4 offset:32768
    ds_read_b128 v[28:31], v4 offset:40960
    ds_read_b128 v[32:35], v4 offset:49152
    ds_read_b128 v[36:39], v4 offset:57344
    s_sub_u32 s56, 128, s52
    s_cmp_lt_u32 s28, 4
    s_cselect_b32 s56, s52, s56
    s_mul_i32 s54, s56, 32896
    s_and_b32 s56, s28, 3
    s_lshl_b32 s56, s56, 13
    s_add_u32 s54, s54, s56
    s_add_u32 s55, s54, 4096
    s_cmp_ge_u32 s52, 64
    s_cselect_b32 s42, 0, s42
    s_cselect_b32 s46, 0, s46
    s_waitcnt lgkmcnt(0)
    s_barrier
L_w2_139:
    v_mfma_f32_32x32x16_bf16 v[72:87], v[136:139], v[104:107], 0
    s_add_u32 m0, s60, 0
    s_nop 0
    buffer_load_dwordx4 v2, s[40:43], s54 offen offset:0 lds
    v_cvt_pk_bf16_f32 v120, v40, v41
    v_cvt_pk_bf16_f32 v121, v42, v43
    v_cvt_pk_bf16_f32 v122, v44, v45
    v_cvt_pk_bf16_f32 v123, v46, v47
    v_cvt_pk_bf16_f32 v124, v48, v49
    v_cvt_pk_bf16_f32 v125, v50, v51
    v_mfma_f32_32x32x16_bf16 v[88:103], v[136:139], v[112:115], 0
    v_cvt_pk_bf16_f32 v126, v52, v53
    v_cvt_pk_bf16_f32 v127, v54, v55
    v_cvt_pk_bf16_f32 v128, v56, v57
    v_cvt_pk_bf16_f32 v129, v58, v59
    v_cvt_pk_bf16_f32 v130, v60, v61
    v_cvt_pk_bf16_f32 v131, v62, v63
    v_mfma_f32_32x32x16_bf16 v[72:87], v[144:147], v[112:115], v[72:87]
    s_add_u32 m0, s60, 0
    s_nop 0
    buffer_load_dwordx4 v3, s[40:43], s54 offen offset:1024 lds
    v_cvt_pk_bf16_f32 v132, v64, v65
    v_cvt_pk_bf16_f32 v133, v66, v67
    v_cvt_pk_bf16_f32 v134, v68, v69
    v_cvt_pk_bf16_f32 v135, v70, v71
    v_lshlrev_b32 v160, 16, v8
    v_and_b32 v176, 0xffff0000, v8
    v_mfma_f32_32x32x16_bf16 v[88:103], v[152:155], v[104:107], v[88:103]
    v_lshlrev_b32 v161, 16, v9
    v_and_b32 v177, 0xffff0000, v9
    v_lshlrev_b32 v162, 16, v10
    v_and_b32 v178, 0xffff0000, v10
    v_lshlrev_b32 v163, 16, v11
    v_and_b32 v179, 0xffff0000, v11
    v_mfma_f32_32x32x16_bf16 v[72:87], v[140:143], v[108:111], v[72:87]
    s_add_u32 m0, s60, 0
    s_nop 0
    buffer_load_dwordx4 v2, s[40:43], s54 offen offset:2048 lds
    v_lshlrev_b32 v164, 16, v12
    v_and_b32 v180, 0xffff0000, v12
    v_lshlrev_b32 v165, 16, v13
    v_and_b32 v181, 0xffff0000, v13
    v_lshlrev_b32 v166, 16, v14
    v_and_b32 v182, 0xffff0000, v14
    v_mfma_f32_32x32x16_bf16 v[88:103], v[140:143], v[116:119], v[88:103]
    v_lshlrev_b32 v167, 16, v15
    v_and_b32 v183, 0xffff0000, v15
    v_lshlrev_b32 v168, 16, v16
    v_and_b32 v184, 0xffff0000, v16
    v_lshlrev_b32 v169, 16, v17
    v_and_b32 v185, 0xffff0000, v17
    v_mfma_f32_32x32x16_bf16 v[72:87], v[148:151], v[116:119], v[72:87]
    s_add_u32 m0, s60, 0
    s_nop 0
    buffer_load_dwordx4 v3, s[40:43], s54 offen offset:3072 lds
    v_lshlrev_b32 v170, 16, v18
    v_and_b32 v186, 0xffff0000, v18
    v_lshlrev_b32 v171, 16, v19
    v_and_b32 v187, 0xffff0000, v19
    v_lshlrev_b32 v172, 16, v20
    v_and_b32 v188, 0xffff0000, v20
    v_mfma_f32_32x32x16_bf16 v[88:103], v[156:159], v[108:111], v[88:103]
    v_lshlrev_b32 v173, 16, v21
    v_and_b32 v189, 0xffff0000, v21
    v_lshlrev_b32 v174, 16, v22
    v_and_b32 v190, 0xffff0000, v22
    v_lshlrev_b32 v175, 16, v23
    v_and_b32 v191, 0xffff0000, v23
    v_mfma_f32_32x32x16_bf16 v[40:55], v[192:195], v[120:123], 0
    s_add_u32 m0, s60, 4096
    s_nop 0
    buffer_load_dwordx4 v2, s[40:43], s55 offen offset:0 lds
    v_lshlrev_b32 v224, 16, v24
    v_and_b32 v240, 0xffff0000, v24
    v_lshlrev_b32 v225, 16, v25
    v_and_b32 v241, 0xffff0000, v25
    v_lshlrev_b32 v226, 16, v26
    v_and_b32 v242, 0xffff0000, v26
    v_lshlrev_b32 v227, 16, v27
    v_and_b32 v243, 0xffff0000, v27
    v_mfma_f32_32x32x16_bf16 v[56:71], v[192:195], v[128:131], 0
    v_lshlrev_b32 v228, 16, v28
    v_and_b32 v244, 0xffff0000, v28
    v_lshlrev_b32 v229, 16, v29
    v_and_b32 v245, 0xffff0000, v29
    v_lshlrev_b32 v230, 16, v30
    v_and_b32 v246, 0xffff0000, v30
    v_lshlrev_b32 v231, 16, v31
    v_and_b32 v247, 0xffff0000, v31
    v_mfma_f32_32x32x16_bf16 v[40:55], v[200:203], v[128:131], v[40:55]
    s_add_u32 m0, s60, 4096
    s_nop 0
    buffer_load_dwordx4 v3, s[40:43], s55 offen offset:1024 lds
    v_pk_mul_f32 v[104:105], v[72:73], v[176:177]
    v_pk_mul_f32 v[106:107], v[74:75], v[178:179]
    v_pk_mul_f32 v[108:109], v[76:77], v[180:181]
    v_pk_mul_f32 v[110:111], v[78:79], v[182:183]
    v_pk_mul_f32 v[112:113], v[80:81], v[184:185]
    v_pk_mul_f32 v[114:115], v[82:83], v[186:187]
    v_pk_mul_f32 v[116:117], v[84:85], v[188:189]
    v_pk_mul_f32 v[118:119], v[86:87], v[190:191]
    v_mfma_f32_32x32x16_bf16 v[56:71], v[208:211], v[120:123], v[56:71]
    v_pk_mul_f32 v[72:73], v[72:73], v[160:161]
    v_pk_mul_f32 v[74:75], v[74:75], v[162:163]
    v_pk_mul_f32 v[76:77], v[76:77], v[164:165]
    v_pk_mul_f32 v[78:79], v[78:79], v[166:167]
    v_pk_mul_f32 v[80:81], v[80:81], v[168:169]
    v_pk_mul_f32 v[82:83], v[82:83], v[170:171]
    v_pk_mul_f32 v[84:85], v[84:85], v[172:173]
    v_pk_mul_f32 v[86:87], v[86:87], v[174:175]
    v_mfma_f32_32x32x16_bf16 v[40:55], v[196:199], v[124:127], v[40:55]
    s_add_u32 m0, s60, 4096
    s_nop 0
    buffer_load_dwordx4 v2, s[40:43], s55 offen offset:2048 lds
    v_pk_fma_f32 v[72:73], v[88:89], v[176:177], v[72:73] neg_lo:[0,1,0] neg_hi:[0,1,0]
    v_pk_fma_f32 v[74:75], v[90:91], v[178:179], v[74:75] neg_lo:[0,1,0] neg_hi:[0,1,0]
    v_pk_fma_f32 v[76:77], v[92:93], v[180:181], v[76:77] neg_lo:[0,1,0] neg_hi:[0,1,0]
    v_pk_fma_f32 v[78:79], v[94:95], v[182:183], v[78:79] neg_lo:[0,1,0] neg_hi:[0,1,0]
    v_pk_fma_f32 v[80:81], v[96:97], v[184:185], v[80:81] neg_lo:[0,1,0] neg_hi:[0,1,0]
    v_pk_fma_f32 v[82:83], v[98:99], v[186:187], v[82:83] neg_lo:[0,1,0] neg_hi:[0,1,0]
    v_pk_fma_f32 v[84:85], v[100:101], v[188:189], v[84:85] neg_lo:[0,1,0] neg_hi:[0,1,0]
    v_pk_fma_f32 v[86:87], v[102:103], v[190:191], v[86:87] neg_lo:[0,1,0] neg_hi:[0,1,0]
    v_mfma_f32_32x32x16_bf16 v[56:71], v[196:199], v[132:135], v[56:71]
    v_pk_fma_f32 v[88:89], v[88:89], v[160:161], v[104:105]
    v_pk_fma_f32 v[90:91], v[90:91], v[162:163], v[106:107]
    v_pk_fma_f32 v[92:93], v[92:93], v[164:165], v[108:109]
    v_pk_fma_f32 v[94:95], v[94:95], v[166:167], v[110:111]
    v_pk_fma_f32 v[96:97], v[96:97], v[168:169], v[112:113]
    v_pk_fma_f32 v[98:99], v[98:99], v[170:171], v[114:115]
    v_pk_fma_f32 v[100:101], v[100:101], v[172:173], v[116:117]
    v_pk_fma_f32 v[102:103], v[102:103], v[174:175], v[118:119]
    v_mfma_f32_32x32x16_bf16 v[40:55], v[204:207], v[132:135], v[40:55]
    s_add_u32 m0, s60, 4096
    s_nop 0
    buffer_load_dwordx4 v3, s[40:43], s55 offen offset:3072 lds
    v_cvt_pk_bf16_f32 v104, v72, v73
    v_cvt_pk_bf16_f32 v105, v74, v75
    v_cvt_pk_bf16_f32 v106, v76, v77
    v_cvt_pk_bf16_f32 v107, v78, v79
    v_cvt_pk_bf16_f32 v108, v80, v81
    v_cvt_pk_bf16_f32 v109, v82, v83
    v_cvt_pk_bf16_f32 v110, v84, v85
    v_cvt_pk_bf16_f32 v111, v86, v87
    v_mfma_f32_32x32x16_bf16 v[56:71], v[212:215], v[124:127], v[56:71]
    v_cvt_pk_bf16_f32 v112, v88, v89
    v_cvt_pk_bf16_f32 v113, v90, v91
    v_cvt_pk_bf16_f32 v114, v92, v93
    v_cvt_pk_bf16_f32 v115, v94, v95
    v_cvt_pk_bf16_f32 v116, v96, v97
    v_cvt_pk_bf16_f32 v117, v98, v99
    v_cvt_pk_bf16_f32 v118, v100, v101
    v_cvt_pk_bf16_f32 v119, v102, v103
    ds_read_b128 v[192:195], v1 offset:38912
    ds_read_b128 v[196:199], v1 offset:39936
    ds_read_b128 v[200:203], v1 offset:40960
    ds_read_b128 v[204:207], v1 offset:41984
    ds_read_b128 v[208:211], v1 offset:43008
    ds_read_b128 v[212:215], v1 offset:44032
    ds_read_b128 v[160:163], v1 offset:8192
    ds_read_b128 v[164:167], v1 offset:9216
    ds_read_b128 v[168:171], v1 offset:10240
    ds_read_b128 v[172:175], v1 offset:11264
    ds_read_b128 v[176:179], v1 offset:12288
    ds_read_b128 v[180:183], v1 offset:13312
    ds_read_b128 v[184:187], v1 offset:14336
    ds_read_b128 v[188:191], v1 offset:15360
    v_mfma_f32_32x32x16_bf16 v[72:87], v[104:107], v[136:139], 0
    v_lshlrev_b32 v232, 16, v32
    v_and_b32 v248, 0xffff0000, v32
    v_lshlrev_b32 v233, 16, v33
    v_and_b32 v249, 0xffff0000, v33
    v_lshlrev_b32 v234, 16, v34
    v_and_b32 v250, 0xffff0000, v34
    v_lshlrev_b32 v235, 16, v35
    v_and_b32 v251, 0xffff0000, v35
    v_mfma_f32_32x32x16_bf16 v[88:103], v[112:115], v[136:139], 0
    v_lshlrev_b32 v236, 16, v36
    v_and_b32 v252, 0xffff0000, v36
    v_lshlrev_b32 v237, 16, v37
    v_and_b32 v253, 0xffff0000, v37
    v_lshlrev_b32 v238, 16, v38
    v_and_b32 v254, 0xffff0000, v38
    v_lshlrev_b32 v239, 16, v39
    v_and_b32 v255, 0xffff0000, v39
    v_mfma_f32_32x32x16_bf16 v[72:87], v[112:115], v[152:155], v[72:87]
    v_pk_mul_f32 v[120:121], v[40:41], v[240:241]
    v_pk_mul_f32 v[122:123], v[42:43], v[242:243]
    v_pk_mul_f32 v[124:125], v[44:45], v[244:245]
    v_pk_mul_f32 v[126:127], v[46:47], v[246:247]
    v_pk_mul_f32 v[128:129], v[48:49], v[248:249]
    v_pk_mul_f32 v[130:131], v[50:51], v[250:251]
    v_pk_mul_f32 v[132:133], v[52:53], v[252:253]
    v_pk_mul_f32 v[134:135], v[54:55], v[254:255]
    v_mfma_f32_32x32x16_bf16 v[88:103], v[104:107], v[144:147], v[88:103]
    v_pk_mul_f32 v[40:41], v[40:41], v[224:225]
    v_pk_mul_f32 v[42:43], v[42:43], v[226:227]
    v_pk_mul_f32 v[44:45], v[44:45], v[228:229]
    v_pk_mul_f32 v[46:47], v[46:47], v[230:231]
    v_pk_mul_f32 v[48:49], v[48:49], v[232:233]
    v_pk_mul_f32 v[50:51], v[50:51], v[234:235]
    v_pk_mul_f32 v[52:53], v[52:53], v[236:237]
    v_pk_mul_f32 v[54:55], v[54:55], v[238:239]
    v_mfma_f32_32x32x16_bf16 v[72:87], v[108:111], v[140:143], v[72:87]
    v_pk_fma_f32 v[40:41], v[56:57], v[240:241], v[40:41] neg_lo:[0,1,0] neg_hi:[0,1,0]
    v_pk_fma_f32 v[42:43], v[58:59], v[242:243], v[42:43] neg_lo:[0,1,0] neg_hi:[0,1,0]
    v_pk_fma_f32 v[44:45], v[60:61], v[244:245], v[44:45] neg_lo:[0,1,0] neg_hi:[0,1,0]
    v_pk_fma_f32 v[46:47], v[62:63], v[246:247], v[46:47] neg_lo:[0,1,0] neg_hi:[0,1,0]
    v_pk_fma_f32 v[48:49], v[64:65], v[248:249], v[48:49] neg_lo:[0,1,0] neg_hi:[0,1,0]
    v_pk_fma_f32 v[50:51], v[66:67], v[250:251], v[50:51] neg_lo:[0,1,0] neg_hi:[0,1,0]
    v_pk_fma_f32 v[52:53], v[68:69], v[252:253], v[52:53] neg_lo:[0,1,0] neg_hi:[0,1,0]
    v_pk_fma_f32 v[54:55], v[70:71], v[254:255], v[54:55] neg_lo:[0,1,0] neg_hi:[0,1,0]
    v_mfma_f32_32x32x16_bf16 v[88:103], v[116:119], v[140:143], v[88:103]
    v_pk_fma_f32 v[56:57], v[56:57], v[224:225], v[120:121]
    v_pk_fma_f32 v[58:59], v[58:59], v[226:227], v[122:123]
    v_pk_fma_f32 v[60:61], v[60:61], v[228:229], v[124:125]
    v_pk_fma_f32 v[62:63], v[62:63], v[230:231], v[126:127]
    v_pk_fma_f32 v[64:65], v[64:65], v[232:233], v[128:129]
    v_pk_fma_f32 v[66:67], v[66:67], v[234:235], v[130:131]
    v_pk_fma_f32 v[68:69], v[68:69], v[236:237], v[132:133]
    v_pk_fma_f32 v[70:71], v[70:71], v[238:239], v[134:135]
    v_mfma_f32_32x32x16_bf16 v[72:87], v[116:119], v[156:159], v[72:87]
    v_cvt_pk_bf16_f32 v120, v40, v41
    v_cvt_pk_bf16_f32 v121, v42, v43
    v_cvt_pk_bf16_f32 v122, v44, v45
    v_cvt_pk_bf16_f32 v123, v46, v47
    v_cvt_pk_bf16_f32 v124, v48, v49
    v_cvt_pk_bf16_f32 v125, v50, v51
    v_cvt_pk_bf16_f32 v126, v52, v53
    v_cvt_pk_bf16_f32 v127, v54, v55
    v_mfma_f32_32x32x16_bf16 v[88:103], v[108:111], v[148:151], v[88:103]
    v_cvt_pk_bf16_f32 v128, v56, v57
    v_cvt_pk_bf16_f32 v129, v58, v59
    v_cvt_pk_bf16_f32 v130, v60, v61
    v_cvt_pk_bf16_f32 v131, v62, v63
    v_cvt_pk_bf16_f32 v132, v64, v65
    v_cvt_pk_bf16_f32 v133, v66, v67
    v_cvt_pk_bf16_f32 v134, v68, v69
    v_cvt_pk_bf16_f32 v135, v70, v71
    s_waitcnt lgkmcnt(0)
    ds_read_b128 v[224:227], v1 offset:24576
    ds_read_b128 v[228:231], v1 offset:25600
    ds_read_b128 v[232:235], v1 offset:26624
    ds_read_b128 v[236:239], v1 offset:27648
    ds_read_b128 v[240:243], v1 offset:28672
    ds_read_b128 v[244:247], v1 offset:29696
    ds_read_b128 v[248:251], v1 offset:30720
    ds_read_b128 v[252:255], v1 offset:31744
    v_mfma_f32_32x32x16_bf16 v[40:55], v[120:123], v[192:195], 0
    v_mfma_f32_32x32x16_bf16 v[56:71], v[128:131], v[192:195], 0
    v_mfma_f32_32x32x16_bf16 v[40:55], v[128:131], v[208:211], v[40:55]
    v_mfma_f32_32x32x16_bf16 v[56:71], v[120:123], v[200:203], v[56:71]
    v_mfma_f32_32x32x16_bf16 v[40:55], v[124:127], v[196:199], v[40:55]
    v_mfma_f32_32x32x16_bf16 v[56:71], v[132:135], v[196:199], v[56:71]
    v_mfma_f32_32x32x16_bf16 v[40:55], v[132:135], v[212:215], v[40:55]
    v_mfma_f32_32x32x16_bf16 v[56:71], v[124:127], v[204:207], v[56:71]
    s_waitcnt lgkmcnt(7)
    ds_read_b128 v[192:195], v1 offset:45056
    ds_read_b128 v[196:199], v1 offset:46080
    ds_read_b128 v[200:203], v1 offset:47104
    ds_read_b128 v[204:207], v1 offset:48128
    ds_read_b128 v[208:211], v1 offset:49152
    ds_read_b128 v[212:215], v1 offset:50176
    ds_read_b128 v[216:219], v1 offset:51200
    ds_read_b128 v[220:223], v1 offset:52224
    s_nop 1
    v_pk_add_f32 v[40:41], v[72:73], v[40:41] neg_lo:[0,1] neg_hi:[0,1]
    v_pk_add_f32 v[42:43], v[74:75], v[42:43] neg_lo:[0,1] neg_hi:[0,1]
    v_pk_add_f32 v[44:45], v[76:77], v[44:45] neg_lo:[0,1] neg_hi:[0,1]
    v_pk_add_f32 v[46:47], v[78:79], v[46:47] neg_lo:[0,1] neg_hi:[0,1]
    v_pk_add_f32 v[48:49], v[80:81], v[48:49] neg_lo:[0,1] neg_hi:[0,1]
    v_pk_add_f32 v[50:51], v[82:83], v[50:51] neg_lo:[0,1] neg_hi:[0,1]
    v_pk_add_f32 v[52:53], v[84:85], v[52:53] neg_lo:[0,1] neg_hi:[0,1]
    v_pk_add_f32 v[54:55], v[86:87], v[54:55] neg_lo:[0,1] neg_hi:[0,1]
    v_pk_add_f32 v[56:57], v[88:89], v[56:57] neg_lo:[0,1] neg_hi:[0,1]
    v_pk_add_f32 v[58:59], v[90:91], v[58:59] neg_lo:[0,1] neg_hi:[0,1]
    v_pk_add_f32 v[60:61], v[92:93], v[60:61] neg_lo:[0,1] neg_hi:[0,1]
    v_pk_add_f32 v[62:63], v[94:95], v[62:63] neg_lo:[0,1] neg_hi:[0,1]
    v_pk_add_f32 v[64:65], v[96:97], v[64:65] neg_lo:[0,1] neg_hi:[0,1]
    v_pk_add_f32 v[66:67], v[98:99], v[66:67] neg_lo:[0,1] neg_hi:[0,1]
    v_pk_add_f32 v[68:69], v[100:101], v[68:69] neg_lo:[0,1] neg_hi:[0,1]
    v_pk_add_f32 v[70:71], v[102:103], v[70:71] neg_lo:[0,1] neg_hi:[0,1]
    v_pk_fma_f32 v[72:73], v[72:73], 2.0, v[40:41] op_sel_hi:[1,0,1] neg_lo:[0,0,1] neg_hi:[0,0,1]
    v_pk_fma_f32 v[74:75], v[74:75], 2.0, v[42:43] op_sel_hi:[1,0,1] neg_lo:[0,0,1] neg_hi:[0,0,1]
    v_pk_fma_f32 v[76:77], v[76:77], 2.0, v[44:45] op_sel_hi:[1,0,1] neg_lo:[0,0,1] neg_hi:[0,0,1]
    v_pk_fma_f32 v[78:79], v[78:79], 2.0, v[46:47] op_sel_hi:[1,0,1] neg_lo:[0,0,1] neg_hi:[0,0,1]
    v_pk_fma_f32 v[80:81], v[80:81], 2.0, v[48:49] op_sel_hi:[1,0,1] neg_lo:[0,0,1] neg_hi:[0,0,1]
    v_pk_fma_f32 v[82:83], v[82:83], 2.0, v[50:51] op_sel_hi:[1,0,1] neg_lo:[0,0,1] neg_hi:[0,0,1]
    v_pk_fma_f32 v[84:85], v[84:85], 2.0, v[52:53] op_sel_hi:[1,0,1] neg_lo:[0,0,1] neg_hi:[0,0,1]
    v_pk_fma_f32 v[86:87], v[86:87], 2.0, v[54:55] op_sel_hi:[1,0,1] neg_lo:[0,0,1] neg_hi:[0,0,1]
    v_pk_fma_f32 v[88:89], v[88:89], 2.0, v[56:57] op_sel_hi:[1,0,1] neg_lo:[0,0,1] neg_hi:[0,0,1]
    v_pk_fma_f32 v[90:91], v[90:91], 2.0, v[58:59] op_sel_hi:[1,0,1] neg_lo:[0,0,1] neg_hi:[0,0,1]
    v_pk_fma_f32 v[92:93], v[92:93], 2.0, v[60:61] op_sel_hi:[1,0,1] neg_lo:[0,0,1] neg_hi:[0,0,1]
    v_pk_fma_f32 v[94:95], v[94:95], 2.0, v[62:63] op_sel_hi:[1,0,1] neg_lo:[0,0,1] neg_hi:[0,0,1]
    v_pk_fma_f32 v[96:97], v[96:97], 2.0, v[64:65] op_sel_hi:[1,0,1] neg_lo:[0,0,1] neg_hi:[0,0,1]
    v_pk_fma_f32 v[98:99], v[98:99], 2.0, v[66:67] op_sel_hi:[1,0,1] neg_lo:[0,0,1] neg_hi:[0,0,1]
    v_pk_fma_f32 v[100:101], v[100:101], 2.0, v[68:69] op_sel_hi:[1,0,1] neg_lo:[0,0,1] neg_hi:[0,0,1]
    v_pk_fma_f32 v[102:103], v[102:103], 2.0, v[70:71] op_sel_hi:[1,0,1] neg_lo:[0,0,1] neg_hi:[0,0,1]
    v_pk_mul_f32 v[104:105], v[72:73], v[176:177]
    v_pk_mul_f32 v[106:107], v[74:75], v[178:179]
    v_pk_mul_f32 v[108:109], v[76:77], v[180:181]
    v_pk_mul_f32 v[110:111], v[78:79], v[182:183]
    v_pk_mul_f32 v[112:113], v[80:81], v[184:185]
    v_pk_mul_f32 v[114:115], v[82:83], v[186:187]
    v_pk_mul_f32 v[116:117], v[84:85], v[188:189]
    v_pk_mul_f32 v[118:119], v[86:87], v[190:191]
    v_pk_mul_f32 v[72:73], v[72:73], v[160:161]
    v_pk_mul_f32 v[74:75], v[74:75], v[162:163]
    v_pk_mul_f32 v[76:77], v[76:77], v[164:165]
    v_pk_mul_f32 v[78:79], v[78:79], v[166:167]
    v_pk_mul_f32 v[80:81], v[80:81], v[168:169]
    v_pk_mul_f32 v[82:83], v[82:83], v[170:171]
    v_pk_mul_f32 v[84:85], v[84:85], v[172:173]
    v_pk_mul_f32 v[86:87], v[86:87], v[174:175]
    v_pk_fma_f32 v[72:73], v[88:89], v[176:177], v[72:73] neg_lo:[0,1,0] neg_hi:[0,1,0]
    v_pk_fma_f32 v[74:75], v[90:91], v[178:179], v[74:75] neg_lo:[0,1,0] neg_hi:[0,1,0]
    v_pk_fma_f32 v[76:77], v[92:93], v[180:181], v[76:77] neg_lo:[0,1,0] neg_hi:[0,1,0]
    v_pk_fma_f32 v[78:79], v[94:95], v[182:183], v[78:79] neg_lo:[0,1,0] neg_hi:[0,1,0]
    v_pk_fma_f32 v[80:81], v[96:97], v[184:185], v[80:81] neg_lo:[0,1,0] neg_hi:[0,1,0]
    v_pk_fma_f32 v[82:83], v[98:99], v[186:187], v[82:83] neg_lo:[0,1,0] neg_hi:[0,1,0]
    v_pk_fma_f32 v[84:85], v[100:101], v[188:189], v[84:85] neg_lo:[0,1,0] neg_hi:[0,1,0]
    v_pk_fma_f32 v[86:87], v[102:103], v[190:191], v[86:87] neg_lo:[0,1,0] neg_hi:[0,1,0]
    v_pk_fma_f32 v[88:89], v[88:89], v[160:161], v[104:105]
    v_pk_fma_f32 v[90:91], v[90:91], v[162:163], v[106:107]
    v_pk_fma_f32 v[92:93], v[92:93], v[164:165], v[108:109]
    v_pk_fma_f32 v[94:95], v[94:95], v[166:167], v[110:111]
    v_pk_fma_f32 v[96:97], v[96:97], v[168:169], v[112:113]
    v_pk_fma_f32 v[98:99], v[98:99], v[170:171], v[114:115]
    v_pk_fma_f32 v[100:101], v[100:101], v[172:173], v[116:117]
    v_pk_fma_f32 v[102:103], v[102:103], v[174:175], v[118:119]
    v_cvt_pk_bf16_f32 v104, v72, v73
    v_cvt_pk_bf16_f32 v105, v74, v75
    v_cvt_pk_bf16_f32 v106, v76, v77
    v_cvt_pk_bf16_f32 v107, v78, v79
    v_cvt_pk_bf16_f32 v108, v80, v81
    v_cvt_pk_bf16_f32 v109, v82, v83
    v_cvt_pk_bf16_f32 v110, v84, v85
    v_cvt_pk_bf16_f32 v111, v86, v87
    v_cvt_pk_bf16_f32 v112, v88, v89
    v_cvt_pk_bf16_f32 v113, v90, v91
    v_cvt_pk_bf16_f32 v114, v92, v93
    v_cvt_pk_bf16_f32 v115, v94, v95
    v_cvt_pk_bf16_f32 v116, v96, v97
    v_cvt_pk_bf16_f32 v117, v98, v99
    v_cvt_pk_bf16_f32 v118, v100, v101
    v_cvt_pk_bf16_f32 v119, v102, v103
    s_cmp_ge_u32 s52, 64
    s_cbranch_scc1 L_n2_140
    s_waitcnt vmcnt(0) lgkmcnt(0)
    s_barrier
    ds_read_b128 v[8:11], v4 offset:0
    ds_read_b128 v[24:27], v5 offset:32768
    ds_read_b128 v[12:15], v4 offset:8192
    ds_read_b128 v[28:31], v5 offset:40960
    ds_read_b128 v[16:19], v4 offset:16384
    ds_read_b128 v[32:35], v5 offset:49152
    ds_read_b128 v[20:23], v4 offset:24576
    ds_read_b128 v[36:39], v5 offset:57344
    s_mul_i32 s54, s52, 65664
    s_lshl_b32 s56, s28, 13
    s_add_u32 s54, s54, s56
    s_add_u32 s55, s54, 4096
    s_waitcnt lgkmcnt(0)
    s_barrier
L_n2_140:
    s_waitcnt lgkmcnt(0)
    ds_read_b128 v[160:163], v1 offset:0
    ds_read_b128 v[164:167], v1 offset:1024
    ds_read_b128 v[168:171], v1 offset:2048
    ds_read_b128 v[172:175], v1 offset:3072
    ds_read_b128 v[176:179], v1 offset:4096
    ds_read_b128 v[180:183], v1 offset:5120
    ds_read_b128 v[184:187], v1 offset:6144
    ds_read_b128 v[188:191], v1 offset:7168
    v_mfma_f32_32x32x16_bf16 v[72:87], v[192:195], v[104:107], 0
    s_add_u32 m0, s60, 0
    s_nop 0
    buffer_load_dwordx4 v2, s[44:47], s54 offen offset:0 lds
    v_pk_mul_f32 v[120:121], v[40:41], v[240:241]
    v_pk_mul_f32 v[122:123], v[42:43], v[242:243]
    v_pk_mul_f32 v[124:125], v[44:45], v[244:245]
    v_pk_mul_f32 v[126:127], v[46:47], v[246:247]
    v_pk_mul_f32 v[128:129], v[48:49], v[248:249]
    v_pk_mul_f32 v[130:131], v[50:51], v[250:251]
    v_mfma_f32_32x32x16_bf16 v[88:103], v[208:211], v[104:107], 0
    v_pk_mul_f32 v[132:133], v[52:53], v[252:253]
    v_pk_mul_f32 v[134:135], v[54:55], v[254:255]
    v_pk_mul_f32 v[40:41], v[40:41], v[224:225]
    v_pk_mul_f32 v[42:43], v[42:43], v[226:227]
    v_pk_mul_f32 v[44:45], v[44:45], v[228:229]
    v_pk_mul_f32 v[46:47], v[46:47], v[230:231]
    v_mfma_f32_32x32x16_bf16 v[72:87], v[196:199], v[108:111], v[72:87]
    s_add_u32 m0, s60, 0
    s_nop 0
    buffer_load_dwordx4 v3, s[44:47], s54 offen offset:1024 lds
    v_pk_mul_f32 v[48:49], v[48:49], v[232:233]
    v_pk_mul_f32 v[50:51], v[50:51], v[234:235]
    v_pk_mul_f32 v[52:53], v[52:53], v[236:237]
    v_pk_mul_f32 v[54:55], v[54:55], v[238:239]
    v_pk_fma_f32 v[40:41], v[56:57], v[240:241], v[40:41] neg_lo:[0,1,0] neg_hi:[0,1,0]
    v_pk_fma_f32 v[42:43], v[58:59], v[242:243], v[42:43] neg_lo:[0,1,0] neg_hi:[0,1,0]
    v_mfma_f32_32x32x16_bf16 v[88:103], v[212:215], v[108:111], v[88:103]
    v_pk_fma_f32 v[44:45], v[60:61], v[244:245], v[44:45] neg_lo:[0,1,0] neg_hi:[0,1,0]
    v_pk_fma_f32 v[46:47], v[62:63], v[246:247], v[46:47] neg_lo:[0,1,0] neg_hi:[0,1,0]
    v_pk_fma_f32 v[48:49], v[64:65], v[248:249], v[48:49] neg_lo:[0,1,0] neg_hi:[0,1,0]
    v_pk_fma_f32 v[50:51], v[66:67], v[250:251], v[50:51] neg_lo:[0,1,0] neg_hi:[0,1,0]
    v_pk_fma_f32 v[52:53], v[68:69], v[252:253], v[52:53] neg_lo:[0,1,0] neg_hi:[0,1,0]
    v_pk_fma_f32 v[54:55], v[70:71], v[254:255], v[54:55] neg_lo:[0,1,0] neg_hi:[0,1,0]
    v_mfma_f32_32x32x16_bf16 v[72:87], v[200:203], v[112:115], v[72:87]
    s_add_u32 m0, s60, 0
    s_nop 0
    buffer_load_dwordx4 v2, s[44:47], s54 offen offset:2048 lds
    v_pk_fma_f32 v[56:57], v[56:57], v[224:225], v[120:121]
    v_pk_fma_f32 v[58:59], v[58:59], v[226:227], v[122:123]
    v_pk_fma_f32 v[60:61], v[60:61], v[228:229], v[124:125]
    v_pk_fma_f32 v[62:63], v[62:63], v[230:231], v[126:127]
    v_pk_fma_f32 v[64:65], v[64:65], v[232:233], v[128:129]
    v_pk_fma_f32 v[66:67], v[66:67], v[234:235], v[130:131]
    v_mfma_f32_32x32x16_bf16 v[88:103], v[216:219], v[112:115], v[88:103]
    v_pk_fma_f32 v[68:69], v[68:69], v[236:237], v[132:133]
    v_pk_fma_f32 v[70:71], v[70:71], v[238:239], v[134:135]
    v_cvt_pk_bf16_f32 v120, v40, v41
    v_cvt_pk_bf16_f32 v121, v42, v43
    v_cvt_pk_bf16_f32 v122, v44, v45
    v_cvt_pk_bf16_f32 v123, v46, v47
    v_mfma_f32_32x32x16_bf16 v[72:87], v[204:207], v[116:119], v[72:87]
    s_add_u32 m0, s60, 0
    s_nop 0
    buffer_load_dwordx4 v3, s[44:47], s54 offen offset:3072 lds
    v_cvt_pk_bf16_f32 v124, v48, v49
    v_cvt_pk_bf16_f32 v125, v50, v51
    v_cvt_pk_bf16_f32 v126, v52, v53
    v_cvt_pk_bf16_f32 v127, v54, v55
    v_cvt_pk_bf16_f32 v128, v56, v57
    v_cvt_pk_bf16_f32 v129, v58, v59
    v_mfma_f32_32x32x16_bf16 v[88:103], v[220:223], v[116:119], v[88:103]
    v_cvt_pk_bf16_f32 v130, v60, v61
    v_cvt_pk_bf16_f32 v131, v62, v63
    v_cvt_pk_bf16_f32 v132, v64, v65
    v_cvt_pk_bf16_f32 v133, v66, v67
    v_cvt_pk_bf16_f32 v134, v68, v69
    v_cvt_pk_bf16_f32 v135, v70, v71
    s_waitcnt lgkmcnt(0)
    ds_read_b128 v[224:227], v1 offset:16384
    ds_read_b128 v[228:231], v1 offset:17408
    ds_read_b128 v[232:235], v1 offset:18432
    ds_read_b128 v[236:239], v1 offset:19456
    ds_read_b128 v[240:243], v1 offset:20480
    ds_read_b128 v[244:247], v1 offset:21504
    ds_read_b128 v[248:251], v1 offset:22528
    ds_read_b128 v[252:255], v1 offset:23552
    s_and_b32 s56, s53, 511
    s_cmp_eq_u32 s56, 0
    s_cbranch_scc1 L_spec_143
    v_mfma_f32_32x32x16_bf16 v[40:55], v[192:195], v[120:123], 0
    s_add_u32 m0, s60, 4096
    s_nop 0
    buffer_load_dwordx4 v2, s[44:47], s55 offen offset:0 lds
    v_mfma_f32_32x32x16_bf16 v[56:71], v[208:211], v[120:123], 0
    v_mfma_f32_32x32x16_bf16 v[40:55], v[196:199], v[124:127], v[40:55]
    s_add_u32 m0, s60, 4096
    s_nop 0
    buffer_load_dwordx4 v3, s[44:47], s55 offen offset:1024 lds
    v_cvt_pk_bf16_f32 v104, v72, v88
    v_cvt_pk_bf16_f32 v105, v73, v89
    v_cvt_pk_bf16_f32 v106, v74, v90
    v_cvt_pk_bf16_f32 v107, v75, v91
    v_cvt_pk_bf16_f32 v108, v80, v96
    v_mfma_f32_32x32x16_bf16 v[56:71], v[212:215], v[124:127], v[56:71]
    v_cvt_pk_bf16_f32 v109, v81, v97
    v_cvt_pk_bf16_f32 v110, v82, v98
    v_cvt_pk_bf16_f32 v111, v83, v99
    v_permlane32_swap_b32 v104, v108
    v_permlane32_swap_b32 v105, v109
    v_mfma_f32_32x32x16_bf16 v[40:55], v[200:203], v[128:131], v[40:55]
    s_add_u32 m0, s60, 4096
    s_nop 0
    buffer_load_dwordx4 v2, s[44:47], s55 offen offset:2048 lds
    v_permlane32_swap_b32 v106, v110
    v_permlane32_swap_b32 v107, v111
    buffer_store_dwordx4 v[104:107], v6, s[48:51], s57 offen offset:0 sc1
    buffer_store_dwordx4 v[108:111], v6, s[48:51], s57 offen offset:1024 sc1
    v_mfma_f32_32x32x16_bf16 v[56:71], v[216:219], v[128:131], v[56:71]
    v_cvt_pk_bf16_f32 v112, v76, v92
    v_cvt_pk_bf16_f32 v113, v77, v93
    v_cvt_pk_bf16_f32 v114, v78, v94
    v_cvt_pk_bf16_f32 v115, v79, v95
    v_cvt_pk_bf16_f32 v116, v84, v100
    v_mfma_f32_32x32x16_bf16 v[40:55], v[204:207], v[132:135], v[40:55]
    s_add_u32 m0, s60, 4096
    s_nop 0
    buffer_load_dwordx4 v3, s[44:47], s55 offen offset:3072 lds
    v_cvt_pk_bf16_f32 v117, v85, v101
    v_cvt_pk_bf16_f32 v118, v86, v102
    v_cvt_pk_bf16_f32 v119, v87, v103
    v_permlane32_swap_b32 v112, v116
    v_permlane32_swap_b32 v113, v117
    v_mfma_f32_32x32x16_bf16 v[56:71], v[220:223], v[132:135], v[56:71]
    v_permlane32_swap_b32 v114, v118
    v_permlane32_swap_b32 v115, v119
    buffer_store_dwordx4 v[112:115], v6, s[48:51], s57 offen offset:2048 sc1
    buffer_store_dwordx4 v[116:119], v6, s[48:51], s57 offen offset:3072 sc1
    s_waitcnt lgkmcnt(7)
    ds_read_b128 v[192:195], v1 offset:8192
    ds_read_b128 v[196:199], v1 offset:9216
    ds_read_b128 v[200:203], v1 offset:10240
    ds_read_b128 v[204:207], v1 offset:11264
    ds_read_b128 v[208:211], v1 offset:12288
    ds_read_b128 v[212:215], v1 offset:13312
    ds_read_b128 v[216:219], v1 offset:14336
    ds_read_b128 v[220:223], v1 offset:15360
L_specd_144:
    v_cvt_pk_bf16_f32 v120, v40, v56
    v_cvt_pk_bf16_f32 v121, v41, v57
    v_cvt_pk_bf16_f32 v122, v42, v58
    v_cvt_pk_bf16_f32 v123, v43, v59
    v_cvt_pk_bf16_f32 v124, v48, v64
    v_cvt_pk_bf16_f32 v125, v49, v65
    v_cvt_pk_bf16_f32 v126, v50, v66
    v_cvt_pk_bf16_f32 v127, v51, v67
    v_permlane32_swap_b32 v120, v124
    v_permlane32_swap_b32 v121, v125
    v_permlane32_swap_b32 v122, v126
    v_permlane32_swap_b32 v123, v127
    buffer_store_dwordx4 v[120:123], v6, s[48:51], s58 offen offset:0 sc1
    buffer_store_dwordx4 v[124:127], v6, s[48:51], s58 offen offset:1024 sc1
    v_cvt_pk_bf16_f32 v128, v44, v60
    v_cvt_pk_bf16_f32 v129, v45, v61
    v_cvt_pk_bf16_f32 v130, v46, v62
    v_cvt_pk_bf16_f32 v131, v47, v63
    v_cvt_pk_bf16_f32 v132, v52, v68
    v_cvt_pk_bf16_f32 v133, v53, v69
    v_cvt_pk_bf16_f32 v134, v54, v70
    v_cvt_pk_bf16_f32 v135, v55, v71
    v_permlane32_swap_b32 v128, v132
    v_permlane32_swap_b32 v129, v133
    v_permlane32_swap_b32 v130, v134
    v_permlane32_swap_b32 v131, v135
    buffer_store_dwordx4 v[128:131], v6, s[48:51], s58 offen offset:2048 sc1
    buffer_store_dwordx4 v[132:135], v6, s[48:51], s58 offen offset:3072 sc1
    s_cmp_lt_u32 s52, 64
    s_cbranch_scc1 L_t2top_137
    s_cmp_lg_u32 s52, 64
    s_cbranch_scc1 L_t2x_146
    s_cmp_lg_u32 s28, 0
    s_cbranch_scc1 L_t2x_146
    s_mov_b32 s59, 1
    s_waitcnt vmcnt(0)
    s_lshl_b32 s35, s34, 2
    s_add_u32 s35, s35, 135168
    v_mov_b32 v104, 141312
    v_mov_b32 v105, 1
    v_mov_b32 v107, s35
    s_mov_b64 exec, 1
    ds_add_rtn_u32 v105, v104, v105 offset:36
    ds_read_b32 v106, v104 offset:28
    s_waitcnt lgkmcnt(0)
    v_readfirstlane_b32 s35, v105
    s_cmp_lg_u32 s35, 7
    s_cbranch_scc1 L_na_147
    s_mov_b32 exec_lo, -1
    s_mov_b32 exec_hi, 0
    v_mbcnt_lo_u32_b32 v106, -1, 0
    v_lshl_add_u32 v107, v106, 7, v107
    v_mov_b32 v106, s31
    buffer_store_dword v106, v107, s[24:27], 0 offen sc1
    s_mov_b64 exec, 1
    ds_write_b32 v104, v105 offset:48
L_na_147:
    s_mov_b64 exec, -1
    v_add_u32 v4, 124928, v1
    s_waitcnt lgkmcnt(0)
    ds_read_b128 v[8:11], v4 offset:0
    ds_read_b128 v[12:15], v4 offset:1024
    ds_read_b128 v[16:19], v4 offset:2048
    ds_read_b128 v[20:23], v4 offset:3072
    ds_read_b128 v[24:27], v4 offset:4096
    ds_read_b128 v[28:31], v4 offset:5120
    ds_read_b128 v[32:35], v4 offset:6144
    ds_read_b128 v[36:39], v4 offset:7168
    s_waitcnt lgkmcnt(0)
    s_branch L_t2top_137
L_w1_138:
    ds_read_b128 v[8:11], v4 offset:8192
    ds_read_b128 v[12:15], v4 offset:9216
    ds_read_b128 v[16:19], v4 offset:10240
    ds_read_b128 v[20:23], v4 offset:11264
    ds_read_b128 v[24:27], v4 offset:12288
    ds_read_b128 v[28:31], v4 offset:13312
    ds_read_b128 v[32:35], v4 offset:14336
    ds_read_b128 v[36:39], v4 offset:15360
    s_waitcnt lgkmcnt(0)
    s_branch L_w2_139
L_spec_143:
    v_mfma_f32_32x32x16_bf16 v[40:55], v[192:195], v[120:123], 0
    s_add_u32 m0, s60, 4096
    s_nop 0
    buffer_load_dwordx4 v2, s[44:47], s55 offen offset:0 lds
    v_mfma_f32_32x32x16_bf16 v[56:71], v[208:211], v[120:123], 0
    v_mfma_f32_32x32x16_bf16 v[40:55], v[196:199], v[124:127], v[40:55]
    s_add_u32 m0, s60, 4096
    s_nop 0
    buffer_load_dwordx4 v3, s[44:47], s55 offen offset:1024 lds
    v_mfma_f32_32x32x16_bf16 v[56:71], v[212:215], v[124:127], v[56:71]
    v_mfma_f32_32x32x16_bf16 v[40:55], v[200:203], v[128:131], v[40:55]
    s_add_u32 m0, s60, 4096
    s_nop 0
    buffer_load_dwordx4 v2, s[44:47], s55 offen offset:2048 lds
    v_mfma_f32_32x32x16_bf16 v[56:71], v[216:219], v[128:131], v[56:71]
    v_mfma_f32_32x32x16_bf16 v[40:55], v[204:207], v[132:135], v[40:55]
    s_add_u32 m0, s60, 4096
    s_nop 0
    buffer_load_dwordx4 v3, s[44:47], s55 offen offset:3072 lds
    v_mfma_f32_32x32x16_bf16 v[56:71], v[220:223], v[132:135], v[56:71]
    s_waitcnt lgkmcnt(7)
    ds_read_b128 v[192:195], v1 offset:8192
    ds_read_b128 v[196:199], v1 offset:9216
    ds_read_b128 v[200:203], v1 offset:10240
    ds_read_b128 v[204:207], v1 offset:11264
    ds_read_b128 v[208:211], v1 offset:12288
    ds_read_b128 v[212:215], v1 offset:13312
    ds_read_b128 v[216:219], v1 offset:14336
    ds_read_b128 v[220:223], v1 offset:15360
    v_pk_add_f32 v[72:73], v[72:73], v[80:81]
    v_pk_mul_f32 v[72:73], v[72:73], 0.5 op_sel_hi:[1,0]
    v_mov_b32 v80, v72
    v_mov_b32 v81, v73
    v_pk_add_f32 v[74:75], v[74:75], v[82:83]
    v_pk_mul_f32 v[74:75], v[74:75], 0.5 op_sel_hi:[1,0]
    v_mov_b32 v82, v74
    v_mov_b32 v83, v75
    v_pk_add_f32 v[76:77], v[76:77], v[84:85]
    v_pk_mul_f32 v[76:77], v[76:77], 0.5 op_sel_hi:[1,0]
    v_mov_b32 v84, v76
    v_mov_b32 v85, v77
    v_pk_add_f32 v[78:79], v[78:79], v[86:87]
    v_pk_mul_f32 v[78:79], v[78:79], 0.5 op_sel_hi:[1,0]
    v_mov_b32 v86, v78
    v_mov_b32 v87, v79
    v_pk_add_f32 v[88:89], v[88:89], v[96:97]
    v_pk_mul_f32 v[88:89], v[88:89], 0.5 op_sel_hi:[1,0]
    v_mov_b32 v96, v88
    v_mov_b32 v97, v89
    v_pk_add_f32 v[90:91], v[90:91], v[98:99]
    v_pk_mul_f32 v[90:91], v[90:91], 0.5 op_sel_hi:[1,0]
    v_mov_b32 v98, v90
    v_mov_b32 v99, v91
    v_pk_add_f32 v[92:93], v[92:93], v[100:101]
    v_pk_mul_f32 v[92:93], v[92:93], 0.5 op_sel_hi:[1,0]
    v_mov_b32 v100, v92
    v_mov_b32 v101, v93
    v_pk_add_f32 v[94:95], v[94:95], v[102:103]
    v_pk_mul_f32 v[94:95], v[94:95], 0.5 op_sel_hi:[1,0]
    v_mov_b32 v102, v94
    v_mov_b32 v103, v95
    v_pk_add_f32 v[40:41], v[40:41], v[48:49]
    v_pk_mul_f32 v[40:41], v[40:41], 0.5 op_sel_hi:[1,0]
    v_mov_b32 v48, v40
    v_mov_b32 v49, v41
    v_pk_add_f32 v[42:43], v[42:43], v[50:51]
    v_pk_mul_f32 v[42:43], v[42:43], 0.5 op_sel_hi:[1,0]
    v_mov_b32 v50, v42
    v_mov_b32 v51, v43
    v_pk_add_f32 v[44:45], v[44:45], v[52:53]
    v_pk_mul_f32 v[44:45], v[44:45], 0.5 op_sel_hi:[1,0]
    v_mov_b32 v52, v44
    v_mov_b32 v53, v45
    v_pk_add_f32 v[46:47], v[46:47], v[54:55]
    v_pk_mul_f32 v[46:47], v[46:47], 0.5 op_sel_hi:[1,0]
    v_mov_b32 v54, v46
    v_mov_b32 v55, v47
    v_pk_add_f32 v[56:57], v[56:57], v[64:65]
    v_pk_mul_f32 v[56:57], v[56:57], 0.5 op_sel_hi:[1,0]
    v_mov_b32 v64, v56
    v_mov_b32 v65, v57
    v_pk_add_f32 v[58:59], v[58:59], v[66:67]
    v_pk_mul_f32 v[58:59], v[58:59], 0.5 op_sel_hi:[1,0]
    v_mov_b32 v66, v58
    v_mov_b32 v67, v59
    v_pk_add_f32 v[60:61], v[60:61], v[68:69]
    v_pk_mul_f32 v[60:61], v[60:61], 0.5 op_sel_hi:[1,0]
    v_mov_b32 v68, v60
    v_mov_b32 v69, v61
    v_pk_add_f32 v[62:63], v[62:63], v[70:71]
    v_pk_mul_f32 v[62:63], v[62:63], 0.5 op_sel_hi:[1,0]
    v_mov_b32 v70, v62
    v_mov_b32 v71, v63
    v_cvt_pk_bf16_f32 v104, v72, v88
    v_cvt_pk_bf16_f32 v105, v73, v89
    v_cvt_pk_bf16_f32 v106, v74, v90
    v_cvt_pk_bf16_f32 v107, v75, v91
    v_cvt_pk_bf16_f32 v108, v80, v96
    v_cvt_pk_bf16_f32 v109, v81, v97
    v_cvt_pk_bf16_f32 v110, v82, v98
    v_cvt_pk_bf16_f32 v111, v83, v99
    v_permlane32_swap_b32 v104, v108
    v_permlane32_swap_b32 v105, v109
    v_permlane32_swap_b32 v106, v110
    v_permlane32_swap_b32 v107, v111
    buffer_store_dwordx4 v[104:107], v6, s[48:51], s57 offen offset:0 sc1
    buffer_store_dwordx4 v[108:111], v6, s[48:51], s57 offen offset:1024 sc1
    v_cvt_pk_bf16_f32 v112, v76, v92
    v_cvt_pk_bf16_f32 v113, v77, v93
    v_cvt_pk_bf16_f32 v114, v78, v94
    v_cvt_pk_bf16_f32 v115, v79, v95
    v_cvt_pk_bf16_f32 v116, v84, v100
    v_cvt_pk_bf16_f32 v117, v85, v101
    v_cvt_pk_bf16_f32 v118, v86, v102
    v_cvt_pk_bf16_f32 v119, v87, v103
    v_permlane32_swap_b32 v112, v116
    v_permlane32_swap_b32 v113, v117
    v_permlane32_swap_b32 v114, v118
    v_permlane32_swap_b32 v115, v119
    buffer_store_dwordx4 v[112:115], v6, s[48:51], s57 offen offset:2048 sc1
    buffer_store_dwordx4 v[116:119], v6, s[48:51], s57 offen offset:3072 sc1
    s_branch L_specd_144
L_t2x_146:
    s_cmp_lg_u32 s59, 0
    s_cbranch_scc1 L_t2m_148
    s_waitcnt vmcnt(0)
    s_lshl_b32 s35, s34, 2
    s_add_u32 s35, s35, 135168
    v_mov_b32 v160, 141312
    v_mov_b32 v161, 1
    v_mov_b32 v163, s35
    s_mov_b64 exec, 1
    ds_add_rtn_u32 v161, v160, v161 offset:36
    ds_read_b32 v162, v160 offset:28
    s_waitcnt lgkmcnt(0)
    v_readfirstlane_b32 s35, v161
    s_cmp_lg_u32 s35, 7
    s_cbranch_scc1 L_na_150
    s_mov_b32 exec_lo, -1
    s_mov_b32 exec_hi, 0
    v_mbcnt_lo_u32_b32 v162, -1, 0
    v_lshl_add_u32 v163, v162, 7, v163
    v_mov_b32 v162, s31
    buffer_store_dword v162, v163, s[24:27], 0 offen sc1
    s_mov_b64 exec, 1
    ds_write_b32 v160, v161 offset:48
L_na_150:
    s_mov_b64 exec, -1
    s_branch L_t2e_149
L_t2m_148:
    s_waitcnt vmcnt(0)
    v_mbcnt_lo_u32_b32 v160, -1, 0
    v_lshlrev_b32 v160, 7, v160
    v_add_u32 v160, 208896, v160
    v_mov_b32 v161, s31
    s_mov_b32 exec_lo, -1
    s_mov_b32 exec_hi, 0
    buffer_store_dword v161, v160, s[24:27], 0 offen sc1
    s_mov_b64 exec, -1
L_t2e_149:
    v_mbcnt_lo_u32_b32 v1, -1, 0
    v_mbcnt_hi_u32_b32 v1, -1, v1
    v_mov_b32 v2, 141312
L_lw_151:
    ds_read_b32 v3, v2 offset:48
    s_waitcnt lgkmcnt(0)
    v_readfirstlane_b32 s58, v3
    s_cmp_lt_u32 s58, 1
    s_cbranch_scc1 L_lw_151
    s_mov_b32 s36, s8
    s_mov_b32 s37, s9
    s_mov_b32 s38, 0xe00000
    s_mov_b32 s39, 0x00020000
    s_sub_u32 s71, s30, 28
    s_lshl_b32 s71, s71, 3
    s_add_u32 s71, s71, s28
    s_bfe_u32 s63, s2, 0x10002
    s_mul_i32 s63, s63, 7340032
    s_bfe_u32 s72, s2, 0x10001
    s_mul_i32 s58, s72, 3672064
    s_add_u32 s67, s63, s58
    s_lshr_b32 s58, s71, 2
    s_mul_i32 s58, s58, 524544
    s_add_u32 s67, s67, s58
    s_and_b32 s58, s71, 3
    s_lshl_b32 s58, s58, 17
    s_add_u32 s67, s67, s58
    s_cmp_ge_u32 s71, 28
    s_cselect_b32 s67, 0x40000000, s67
    v_lshrrev_b32 v2, 1, v1
    v_lshlrev_b32 v2, 12, v2
    v_and_b32 v3, 1, v1
    v_lshl_add_u32 v2, v3, 7, v2
    buffer_load_dword v254, v2, s[36:39], s67 offen
    s_mov_b32 s73, 0x6543210
    s_mov_b32 s58, 0x5461032
    s_bitcmp1_b32 s29, 0
    s_cselect_b32 s73, s58, s73
    s_lshl_b32 s72, s72, 11
    s_add_u32 s63, s63, s72
    s_lshl_b32 s58, s71, 14
    s_add_u32 s63, s63, s58
    v_lshrrev_b32 v2, 4, v1
    v_lshlrev_b32 v2, 12, v2
    v_and_b32 v3, 15, v1
    v_lshl_add_u32 v2, v3, 7, v2
    s_cmp_lt_u32 s28, 4
    s_cbranch_scc1 L_fc_152
    s_and_b32 s70, s28, 3
    s_lshr_b32 s58, s29, 2
    s_lshl_b32 s58, s58, 5
    s_add_u32 s81, s30, s58
    s_and_b32 s58, s29, 3
    s_lshl_b32 s58, s58, 8
    s_add_u32 s81, s81, s58
    s_lshl_b32 s58, s70, 6
    s_add_u32 s81, s81, s58
    s_lshl_b32 s81, s81, 11
    s_add_u32 s82, s81, 2097152
    v_and_b32 v2, 31, v1
    v_lshrrev_b32 v3, 5, v1
    v_lshlrev_b32 v11, 6, v2
    v_lshl_add_u32 v11, v3, 4, v11
    s_mov_b32 s44, s12
    s_mov_b32 s45, s13
    s_mov_b32 s46, 0x400000
    s_mov_b32 s47, 0x00020000
    buffer_load_dwordx4 v[176:179], v11, s[44:47], s81 offen offset:0
    buffer_load_dwordx4 v[180:183], v11, s[44:47], s81 offen offset:32
    buffer_load_dwordx4 v[184:187], v11, s[44:47], s82 offen offset:0
    buffer_load_dwordx4 v[188:191], v11, s[44:47], s82 offen offset:32
    v_and_b32 v144, 31, v1
    v_lshrrev_b32 v145, 5, v1
    v_cvt_f32_u32 v144, v144
    v_cvt_f32_u32 v145, v145
    v_mul_f32 v146, v144, v145
    v_mul_f32 v146, 0x3e000000, v146
    v_fmamk_f32 v128, v144, 0x00000000, v146
    v_fmamk_f32 v129, v144, 0x3d000000, v146
    v_fmamk_f32 v130, v144, 0x3d800000, v146
    v_fmamk_f32 v131, v144, 0x3dc00000, v146
    v_fmamk_f32 v132, v144, 0x3e800000, v146
    v_fmamk_f32 v133, v144, 0x3e900000, v146
    v_fmamk_f32 v134, v144, 0x3ea00000, v146
    v_fmamk_f32 v135, v144, 0x3eb00000, v146
    v_fmamk_f32 v136, v144, 0x3f000000, v146
    v_fmamk_f32 v137, v144, 0x3f080000, v146
    v_fmamk_f32 v138, v144, 0x3f100000, v146
    v_fmamk_f32 v139, v144, 0x3f180000, v146
    v_fmamk_f32 v140, v144, 0x3f400000, v146
    v_fmamk_f32 v141, v144, 0x3f480000, v146
    v_fmamk_f32 v142, v144, 0x3f500000, v146
    v_fmamk_f32 v143, v144, 0x3f580000, v146
    v_cos_f32 v112, v128
    v_sin_f32 v128, v128
    v_cos_f32 v113, v129
    v_sin_f32 v129, v129
    v_cos_f32 v114, v130
    v_sin_f32 v130, v130
    v_cos_f32 v115, v131
    v_sin_f32 v131, v131
    v_cos_f32 v116, v132
    v_sin_f32 v132, v132
    v_cos_f32 v117, v133
    v_sin_f32 v133, v133
    v_cos_f32 v118, v134
    v_sin_f32 v134, v134
    v_cos_f32 v119, v135
    v_sin_f32 v135, v135
    v_cos_f32 v120, v136
    v_sin_f32 v136, v136
    v_cos_f32 v121, v137
    v_sin_f32 v137, v137
    v_cos_f32 v122, v138
    v_sin_f32 v138, v138
    v_cos_f32 v123, v139
    v_sin_f32 v139, v139
    v_cos_f32 v124, v140
    v_sin_f32 v140, v140
    v_cos_f32 v125, v141
    v_sin_f32 v141, v141
    v_cos_f32 v126, v142
    v_sin_f32 v142, v142
    v_cos_f32 v127, v143
    v_sin_f32 v143, v143
    v_cvt_pk_bf16_f32 v56, v112, v113
    v_cvt_pk_bf16_f32 v57, v114, v115
    v_cvt_pk_bf16_f32 v58, v116, v117
    v_cvt_pk_bf16_f32 v59, v118, v119
    v_cvt_pk_bf16_f32 v60, v120, v121
    v_cvt_pk_bf16_f32 v61, v122, v123
    v_cvt_pk_bf16_f32 v62, v124, v125
    v_cvt_pk_bf16_f32 v63, v126, v127
    v_cvt_pk_bf16_f32 v64, v128, v129
    v_cvt_pk_bf16_f32 v65, v130, v131
    v_cvt_pk_bf16_f32 v66, v132, v133
    v_cvt_pk_bf16_f32 v67, v134, v135
    v_cvt_pk_bf16_f32 v68, v136, v137
    v_cvt_pk_bf16_f32 v69, v138, v139
    v_cvt_pk_bf16_f32 v70, v140, v141
    v_cvt_pk_bf16_f32 v71, v142, v143
    v_xor_b32 v72, 0x80008000, v64
    v_xor_b32 v73, 0x80008000, v65
    v_xor_b32 v74, 0x80008000, v66
    v_xor_b32 v75, 0x80008000, v67
    v_xor_b32 v76, 0x80008000, v68
    v_xor_b32 v77, 0x80008000, v69
    v_xor_b32 v78, 0x80008000, v70
    v_xor_b32 v79, 0x80008000, v71
    v_cvt_pk_bf16_f32 v80, v112, -v128
    v_cvt_pk_bf16_f32 v96, v128, v112
    v_cvt_pk_bf16_f32 v81, v113, -v129
    v_cvt_pk_bf16_f32 v97, v129, v113
    v_cvt_pk_bf16_f32 v82, v114, -v130
    v_cvt_pk_bf16_f32 v98, v130, v114
    v_cvt_pk_bf16_f32 v83, v115, -v131
    v_cvt_pk_bf16_f32 v99, v131, v115
    v_cvt_pk_bf16_f32 v84, v116, -v132
    v_cvt_pk_bf16_f32 v100, v132, v116
    v_cvt_pk_bf16_f32 v85, v117, -v133
    v_cvt_pk_bf16_f32 v101, v133, v117
    v_cvt_pk_bf16_f32 v86, v118, -v134
    v_cvt_pk_bf16_f32 v102, v134, v118
    v_cvt_pk_bf16_f32 v87, v119, -v135
    v_cvt_pk_bf16_f32 v103, v135, v119
    v_cvt_pk_bf16_f32 v88, v120, -v136
    v_cvt_pk_bf16_f32 v104, v136, v120
    v_cvt_pk_bf16_f32 v89, v121, -v137
    v_cvt_pk_bf16_f32 v105, v137, v121
    v_cvt_pk_bf16_f32 v90, v122, -v138
    v_cvt_pk_bf16_f32 v106, v138, v122
    v_cvt_pk_bf16_f32 v91, v123, -v139
    v_cvt_pk_bf16_f32 v107, v139, v123
    v_cvt_pk_bf16_f32 v92, v124, -v140
    v_cvt_pk_bf16_f32 v108, v140, v124
    v_cvt_pk_bf16_f32 v93, v125, -v141
    v_cvt_pk_bf16_f32 v109, v141, v125
    v_cvt_pk_bf16_f32 v94, v126, -v142
    v_cvt_pk_bf16_f32 v110, v142, v126
    v_cvt_pk_bf16_f32 v95, v127, -v143
    v_cvt_pk_bf16_f32 v111, v143, v127
    v_mul_f32 v146, v144, v145
    v_mul_f32 v146, 0x3b800000, v146
    v_fmamk_f32 v128, v144, 0x00000000, v146
    v_fmamk_f32 v129, v144, 0x3a800000, v146
    v_fmamk_f32 v130, v144, 0x3b000000, v146
    v_fmamk_f32 v131, v144, 0x3b400000, v146
    v_fmamk_f32 v132, v144, 0x3c000000, v146
    v_fmamk_f32 v133, v144, 0x3c100000, v146
    v_fmamk_f32 v134, v144, 0x3c200000, v146
    v_fmamk_f32 v135, v144, 0x3c300000, v146
    v_fmamk_f32 v136, v144, 0x3c800000, v146
    v_fmamk_f32 v137, v144, 0x3c880000, v146
    v_fmamk_f32 v138, v144, 0x3c900000, v146
    v_fmamk_f32 v139, v144, 0x3c980000, v146
    v_fmamk_f32 v140, v144, 0x3cc00000, v146
    v_fmamk_f32 v141, v144, 0x3cc80000, v146
    v_fmamk_f32 v142, v144, 0x3cd00000, v146
    v_fmamk_f32 v143, v144, 0x3cd80000, v146
    v_cos_f32 v112, v128
    v_sin_f32 v128, v128
    v_cos_f32 v113, v129
    v_sin_f32 v129, v129
    v_cos_f32 v114, v130
    v_sin_f32 v130, v130
    v_cos_f32 v115, v131
    v_sin_f32 v131, v131
    v_cos_f32 v116, v132
    v_sin_f32 v132, v132
    v_cos_f32 v117, v133
    v_sin_f32 v133, v133
    v_cos_f32 v118, v134
    v_sin_f32 v134, v134
    v_cos_f32 v119, v135
    v_sin_f32 v135, v135
    v_cos_f32 v120, v136
    v_sin_f32 v136, v136
    v_cos_f32 v121, v137
    v_sin_f32 v137, v137
    v_cos_f32 v122, v138
    v_sin_f32 v138, v138
    v_cos_f32 v123, v139
    v_sin_f32 v139, v139
    v_cos_f32 v124, v140
    v_sin_f32 v140, v140
    v_cos_f32 v125, v141
    v_sin_f32 v141, v141
    v_cos_f32 v126, v142
    v_sin_f32 v142, v142
    v_cos_f32 v127, v143
    v_sin_f32 v143, v143
    v_mul_f32 v112, 0x35000000, v112
    v_mul_f32 v128, 0x35000000, v128
    v_mul_f32 v113, 0x35000000, v113
    v_mul_f32 v129, 0x35000000, v129
    v_mul_f32 v114, 0x35000000, v114
    v_mul_f32 v130, 0x35000000, v130
    v_mul_f32 v115, 0x35000000, v115
    v_mul_f32 v131, 0x35000000, v131
    v_mul_f32 v116, 0x35000000, v116
    v_mul_f32 v132, 0x35000000, v132
    v_mul_f32 v117, 0x35000000, v117
    v_mul_f32 v133, 0x35000000, v133
    v_mul_f32 v118, 0x35000000, v118
    v_mul_f32 v134, 0x35000000, v134
    v_mul_f32 v119, 0x35000000, v119
    v_mul_f32 v135, 0x35000000, v135
    v_mul_f32 v120, 0x35000000, v120
    v_mul_f32 v136, 0x35000000, v136
    v_mul_f32 v121, 0x35000000, v121
    v_mul_f32 v137, 0x35000000, v137
    v_mul_f32 v122, 0x35000000, v122
    v_mul_f32 v138, 0x35000000, v138
    v_mul_f32 v123, 0x35000000, v123
    v_mul_f32 v139, 0x35000000, v139
    v_mul_f32 v124, 0x35000000, v124
    v_mul_f32 v140, 0x35000000, v140
    v_mul_f32 v125, 0x35000000, v125
    v_mul_f32 v141, 0x35000000, v141
    v_mul_f32 v126, 0x35000000, v126
    v_mul_f32 v142, 0x35000000, v142
    v_mul_f32 v127, 0x35000000, v127
    v_mul_f32 v143, 0x35000000, v143
    s_lshl_b32 s69, s70, 12
    s_add_u32 s69, s69, 65536
    v_and_b32 v14, 31, v1
    v_lshlrev_b32 v14, 2, v14
    s_lshl_b32 s58, s30, 7
    s_add_u32 s58, s58, 135168
    v_add_u32 v14, s58, v14
    v_mov_b32 v15, 141312
    v_mov_b32 v16, 1
    v_mov_b32 v19, s31
    s_and_b32 s58, s29, 1
    s_lshl_b32 s58, s58, 2
    s_and_b32 s57, s30, 3
    s_add_u32 s57, s57, s58
    s_lshl_b32 s57, s57, 11
    s_bfe_u32 s63, s2, 0x10002
    s_bfe_u32 s58, s2, 0x10001
    s_lshl_b32 s58, s58, 3
    s_lshr_b32 s56, s30, 2
    s_add_u32 s56, s56, s58
    s_lshl_b32 s56, s56, 8
    s_mul_i32 s64, s63, 7340032
    s_add_u32 s64, s64, s56
    s_mul_i32 s65, s63, 3670016
    s_add_u32 s65, s65, s57
    s_and_b32 s58, s30, 3
    s_mul_i32 s62, s58, 1
    s_lshr_b32 s58, s30, 2
    s_mul_i32 s58, s58, 1
    s_add_u32 s62, s62, s58
    s_and_b32 s58, s29, 1
    s_mul_i32 s58, s58, 0
    s_add_u32 s62, s62, s58
    s_and_b32 s62, s62, 3
    v_lshrrev_b32 v2, 4, v1
    v_and_b32 v3, 15, v1
    v_lshlrev_b32 v4, 2, v2
    v_xor_b32 v3, v3, v4
    v_lshlrev_b32 v3, 4, v3
    s_lshl_b32 s58, s70, 4
    s_add_u32 s58, s58, 0
    v_add_u32 v5, s58, v2
    v_lshlrev_b32 v5, 12, v5
    v_add3_u32 v5, v5, v3, s64
    s_lshl_b32 s58, s70, 4
    s_add_u32 s58, s58, 8
    v_add_u32 v6, s58, v2
    v_lshlrev_b32 v6, 12, v6
    v_add3_u32 v6, v6, v3, s64
    v_subrev_u32 v6, 1024, v6
    s_lshl_b32 s58, s70, 4
    s_add_u32 s58, s58, 4
    v_add_u32 v7, s58, v2
    v_lshlrev_b32 v7, 12, v7
    v_add3_u32 v7, v7, v3, s64
    v_subrev_u32 v7, 2048, v7
    s_lshl_b32 s58, s70, 4
    s_add_u32 s58, s58, 12
    v_add_u32 v8, s58, v2
    v_lshlrev_b32 v8, 12, v8
    v_add3_u32 v8, v8, v3, s64
    v_subrev_u32 v8, 3072, v8
    s_mov_b32 s71, 0
    v_lshlrev_b32 v2, 4, v1
    v_add_u32 v2, s65, v2
    s_lshl_b32 s58, s70, 15
    v_add_u32 v9, s58, v2
    v_add_u32 v10, 14336, v9
    s_mov_b32 s71, 0
    s_mov_b32 s72, 0
    s_mov_b32 s73, 0x6543210
    s_mov_b32 s58, 0x5461032
    s_bitcmp1_b32 s29, 0
    s_cselect_b32 s73, s58, s73
    s_mov_b32 s71, -1
    s_mov_b64 s[78:79], 0
    s_mov_b32 s80, 131072
    s_lshr_b32 s58, s57, 10
    s_add_u32 s58, s58, s63
    s_lshl_b32 s58, s58, 11
    s_add_u32 s58, s58, 147456
    v_min_u32 v17, 13, v1
    v_lshl_add_u32 v17, v17, 7, s58
    v_lshrrev_b32 v2, 1, v1
    s_lshl_b32 s58, s70, 7
    v_add_u32 v2, s58, v2
    v_mul_u32_u24 v2, 8320, v2
    v_and_b32 v3, 1, v1
    v_lshl_add_u32 v4, v3, 4, v2
    s_lshl_b32 s58, s29, 5
    s_add_u32 s83, s30, s58
    s_lshl_b32 s83, s83, 5
    s_add_u32 s84, s83, 265216
    s_add_u32 s85, s83, 530432
    s_add_u32 s86, s83, 795648
    v_and_b32 v2, 31, v1
    v_lshrrev_b32 v3, 5, v1
    v_lshl_add_u32 v2, v3, 7, v2
    v_lshlrev_b32 v2, 5, v2
    s_lshl_b32 s58, s70, 2
    s_add_u32 s58, s58, 98304
    v_add_u32 v12, s58, v2
    s_add_u32 s58, s58, 5136
    v_sub_u32 v13, s58, v2
    s_mov_b32 s36, s8
    s_mov_b32 s37, s9
    s_mov_b32 s38, 0xe00000
    s_mov_b32 s39, 0x00020000
    s_add_u32 s48, s18, 0x2000000
    s_addc_u32 s49, s19, 0
    s_mov_b32 s50, 0x412080
    s_mov_b32 s51, 0x00020000
    s_add_u32 s52, s18, 0x2800000
    s_addc_u32 s53, s19, 0
    s_mov_b32 s54, 0x400000
    s_mov_b32 s55, 0x00020000
    s_lshl_b32 s58, s29, 2
    s_add_u32 s58, s58, s70
    s_lshl_b32 s58, s58, 5
    s_add_u32 s58, s58, s30
    s_lshl_b32 s58, s58, 2
    s_add_u32 s58, s58, 139264
    v_mov_b32 v2, s58
    s_mov_b32 s74, 99
    s_add_u32 s40, s18, 0x1800000
    s_addc_u32 s41, s19, 0
    s_mov_b32 s42, 0x700000
    s_mov_b32 s43, 0x00020000
L_kn_153:
    s_add_u32 s71, s71, 1
    s_add_u32 s58, s71, s62
    s_and_b32 s59, s71, 28
    s_lshr_b32 s59, s73, s59
    s_and_b32 s59, s59, 7
    s_and_b32 s58, s58, 3
    s_lshl2_add_u32 s58, s59, s58
    s_lshr_b32 s75, s58, 1
    s_cmp_eq_u32 s75, s74
    s_cbranch_scc1 L_kn_153
    s_mul_i32 s67, s58, 262144
    s_mul_i32 s68, s58, 131072
    s_branch L_seamL_4
L_f0_48:
    s_and_b32 s66, s70, 2
    s_lshl_b32 s66, s66, 1
    s_add_u32 s66, s66, 4
    s_add_u32 s58, s66, s62
    s_and_b32 s59, s66, 28
    s_lshr_b32 s59, s73, s59
    s_and_b32 s59, s59, 7
    s_and_b32 s58, s58, 3
    s_lshl2_add_u32 s58, s59, s58
    s_lshl_b32 s58, s58, 1
    s_and_b32 s59, s70, 1
    s_add_u32 s58, s58, s59
    s_lshl_b32 s58, s58, 17
    s_add_u32 s58, s58, s64
    v_lshrrev_b32 v18, 1, v1
    v_lshlrev_b32 v18, 12, v18
    v_and_b32 v3, 1, v1
    v_lshl_add_u32 v18, v3, 7, v18
    buffer_load_dword v254, v18, s[36:39], s58 offen
L_tc_154:
    s_waitcnt vmcnt(1)
    s_mov_b64 exec, 1
    ds_add_u32 v15, v16 offset:12
    s_mov_b64 exec, -1
L_lw_155:
    ds_read_b32 v18, v15 offset:12
    s_waitcnt lgkmcnt(0)
    v_readfirstlane_b32 s58, v18
    s_cmp_lt_u32 s58, 4
    s_cbranch_scc1 L_lw_155
    ds_read_b32 v24, v12 offset:0
    ds_read_b32 v25, v12 offset:1024
    ds_read_b32 v26, v12 offset:2048
    ds_read_b32 v27, v12 offset:3072
    ds_read_b32 v28, v12 offset:8192
    ds_read_b32 v29, v12 offset:9216
    ds_read_b32 v30, v12 offset:10240
    ds_read_b32 v31, v12 offset:11264
    ds_read_b32 v32, v13 offset:11264
    ds_read_b32 v33, v13 offset:10240
    ds_read_b32 v34, v13 offset:9216
    ds_read_b32 v35, v13 offset:8192
    s_waitcnt lgkmcnt(8)
    ds_read_b32 v36, v13 offset:3072
    ds_read_b32 v37, v13 offset:2048
    ds_read_b32 v38, v13 offset:1024
    ds_read_b32 v39, v13 offset:0
    v_permlane32_swap_b32 v176, v178
    v_permlane32_swap_b32 v177, v179
    v_permlane32_swap_b32 v180, v182
    v_permlane32_swap_b32 v181, v183
    v_permlane32_swap_b32 v184, v186
    v_permlane32_swap_b32 v185, v187
    v_permlane32_swap_b32 v188, v190
    v_permlane32_swap_b32 v189, v191
    v_mfma_f32_32x32x16_bf16 v[144:159], v[24:27], v[80:83], 0
    v_mfma_f32_32x32x16_bf16 v[160:175], v[24:27], v[96:99], 0
    s_waitcnt lgkmcnt(8)
    v_mfma_f32_32x32x16_bf16 v[144:159], v[28:31], v[84:87], v[144:159]
    v_mfma_f32_32x32x16_bf16 v[160:175], v[28:31], v[100:103], v[160:175]
    s_waitcnt lgkmcnt(4)
    v_mfma_f32_32x32x16_bf16 v[144:159], v[32:35], v[88:91], v[144:159]
    v_mfma_f32_32x32x16_bf16 v[160:175], v[32:35], v[104:107], v[160:175]
    s_waitcnt lgkmcnt(0)
    v_mfma_f32_32x32x16_bf16 v[144:159], v[36:39], v[92:95], v[144:159]
    v_mfma_f32_32x32x16_bf16 v[160:175], v[36:39], v[108:111], v[160:175]
    s_nop 10
    v_mul_f32 v40, v144, v128
    v_mul_f32 v41, v145, v129
    v_mul_f32 v42, v146, v130
    v_mul_f32 v43, v147, v131
    v_mul_f32 v44, v148, v132
    v_mul_f32 v45, v149, v133
    v_mul_f32 v46, v150, v134
    v_mul_f32 v47, v151, v135
    v_mul_f32 v48, v152, v136
    v_mul_f32 v49, v153, v137
    v_mul_f32 v50, v154, v138
    v_mul_f32 v51, v155, v139
    v_mul_f32 v52, v156, v140
    v_mul_f32 v53, v157, v141
    v_mul_f32 v54, v158, v142
    v_mul_f32 v55, v159, v143
    v_mul_f32 v144, v144, v112
    v_mul_f32 v145, v145, v113
    v_mul_f32 v146, v146, v114
    v_mul_f32 v147, v147, v115
    v_mul_f32 v148, v148, v116
    v_mul_f32 v149, v149, v117
    v_mul_f32 v150, v150, v118
    v_mul_f32 v151, v151, v119
    v_mul_f32 v152, v152, v120
    v_mul_f32 v153, v153, v121
    v_mul_f32 v154, v154, v122
    v_mul_f32 v155, v155, v123
    v_mul_f32 v156, v156, v124
    v_mul_f32 v157, v157, v125
    v_mul_f32 v158, v158, v126
    v_mul_f32 v159, v159, v127
    v_fma_f32 v144, -v160, v128, v144
    v_fma_f32 v145, -v161, v129, v145
    v_fma_f32 v146, -v162, v130, v146
    v_fma_f32 v147, -v163, v131, v147
    v_fma_f32 v148, -v164, v132, v148
    v_fma_f32 v149, -v165, v133, v149
    v_fma_f32 v150, -v166, v134, v150
    v_fma_f32 v151, -v167, v135, v151
    v_fma_f32 v152, -v168, v136, v152
    v_fma_f32 v153, -v169, v137, v153
    v_fma_f32 v154, -v170, v138, v154
    v_fma_f32 v155, -v171, v139, v155
    v_fma_f32 v156, -v172, v140, v156
    v_fma_f32 v157, -v173, v141, v157
    v_fma_f32 v158, -v174, v142, v158
    v_fma_f32 v159, -v175, v143, v159
    v_fma_f32 v160, v160, v112, v40
    v_fma_f32 v161, v161, v113, v41
    v_fma_f32 v162, v162, v114, v42
    v_fma_f32 v163, v163, v115, v43
    v_fma_f32 v164, v164, v116, v44
    v_fma_f32 v165, v165, v117, v45
    v_fma_f32 v166, v166, v118, v46
    v_fma_f32 v167, v167, v119, v47
    v_fma_f32 v168, v168, v120, v48
    v_fma_f32 v169, v169, v121, v49
    v_fma_f32 v170, v170, v122, v50
    v_fma_f32 v171, v171, v123, v51
    v_fma_f32 v172, v172, v124, v52
    v_fma_f32 v173, v173, v125, v53
    v_fma_f32 v174, v174, v126, v54
    v_fma_f32 v175, v175, v127, v55
    v_cvt_pk_bf16_f32 v24, v144, v145
    v_cvt_pk_bf16_f32 v25, v146, v147
    v_cvt_pk_bf16_f32 v26, v148, v149
    v_cvt_pk_bf16_f32 v27, v150, v151
    v_cvt_pk_bf16_f32 v28, v152, v153
    v_cvt_pk_bf16_f32 v29, v154, v155
    v_cvt_pk_bf16_f32 v30, v156, v157
    v_cvt_pk_bf16_f32 v31, v158, v159
    v_cvt_pk_bf16_f32 v32, v160, v161
    v_cvt_pk_bf16_f32 v33, v162, v163
    v_cvt_pk_bf16_f32 v34, v164, v165
    v_cvt_pk_bf16_f32 v35, v166, v167
    v_cvt_pk_bf16_f32 v36, v168, v169
    v_cvt_pk_bf16_f32 v37, v170, v171
    v_cvt_pk_bf16_f32 v38, v172, v173
    v_cvt_pk_bf16_f32 v39, v174, v175
    v_lshlrev_b32 v144, 16, v176
    v_and_b32 v145, 0xffff0000, v176
    v_lshlrev_b32 v146, 16, v177
    v_and_b32 v147, 0xffff0000, v177
    v_lshlrev_b32 v148, 16, v178
    v_and_b32 v149, 0xffff0000, v178
    v_lshlrev_b32 v150, 16, v179
    v_and_b32 v151, 0xffff0000, v179
    v_lshlrev_b32 v152, 16, v180
    v_and_b32 v153, 0xffff0000, v180
    v_lshlrev_b32 v154, 16, v181
    v_and_b32 v155, 0xffff0000, v181
    v_lshlrev_b32 v156, 16, v182
    v_and_b32 v157, 0xffff0000, v182
    v_lshlrev_b32 v158, 16, v183
    v_and_b32 v159, 0xffff0000, v183
    v_lshlrev_b32 v160, 16, v184
    v_and_b32 v161, 0xffff0000, v184
    v_lshlrev_b32 v162, 16, v185
    v_and_b32 v163, 0xffff0000, v185
    v_lshlrev_b32 v164, 16, v186
    v_and_b32 v165, 0xffff0000, v186
    v_lshlrev_b32 v166, 16, v187
    v_and_b32 v167, 0xffff0000, v187
    v_lshlrev_b32 v168, 16, v188
    v_and_b32 v169, 0xffff0000, v188
    v_lshlrev_b32 v170, 16, v189
    v_and_b32 v171, 0xffff0000, v189
    v_lshlrev_b32 v172, 16, v190
    v_and_b32 v173, 0xffff0000, v190
    v_lshlrev_b32 v174, 16, v191
    v_and_b32 v175, 0xffff0000, v191
    v_mfma_f32_32x32x16_bf16 v[144:159], v[24:27], v[56:59], v[144:159]
    s_nop 0
    v_mfma_f32_32x32x16_bf16 v[160:175], v[32:35], v[56:59], v[160:175]
    v_mfma_f32_32x32x16_bf16 v[144:159], v[32:35], v[72:75], v[144:159]
    v_mfma_f32_32x32x16_bf16 v[160:175], v[24:27], v[64:67], v[160:175]
    v_mfma_f32_32x32x16_bf16 v[144:159], v[28:31], v[60:63], v[144:159]
    v_mfma_f32_32x32x16_bf16 v[160:175], v[36:39], v[60:63], v[160:175]
    v_mfma_f32_32x32x16_bf16 v[144:159], v[36:39], v[76:79], v[144:159]
    v_mfma_f32_32x32x16_bf16 v[160:175], v[28:31], v[68:71], v[160:175]
    s_barrier
    s_cmp_lg_u32 s70, 0
    s_cbranch_scc1 L_no_158
    s_bitcmp1_b32 s78, s75
    s_cbranch_scc1 L_ns_156
    s_branch L_nf_159
L_nr_157:
    s_bitcmp1_b32 s78, s75
    s_cbranch_scc1 L_ns_156
    s_sub_u32 s80, s80, 1
    s_cbranch_scc1 L_ns_156
    s_sleep 2
L_nf_159:
    buffer_load_dword v18, v17, s[24:27], 0 offen sc1
    s_waitcnt vmcnt(0)
    v_cmp_eq_u32 s[78:79], s31, v18
    s_branch L_nr_157
L_ns_156:
    s_mov_b64 exec, 1
    ds_add_u32 v15, v16 offset:8
    s_mov_b64 exec, -1
    s_branch L_ne_160
L_no_158:
L_lw_161:
    ds_read_b32 v18, v15 offset:8
    s_waitcnt lgkmcnt(0)
    v_readfirstlane_b32 s58, v18
    s_cmp_lt_u32 s58, 1
    s_cbranch_scc1 L_lw_161
L_ne_160:
    s_mov_b32 m0, s69
    s_nop 0
    buffer_load_dwordx4 v5, s[36:39], s67 offen offset:0  lds
    buffer_load_dwordx4 v6, s[36:39], s67 offen offset:1024  lds
    buffer_load_dwordx4 v7, s[36:39], s67 offen offset:2048  lds
    buffer_load_dwordx4 v8, s[36:39], s67 offen offset:3072  lds
    s_add_u32 m0, s69, 16384
    s_nop 0
    buffer_load_dwordx4 v9, s[40:43], s68 offen offset:0  lds
    buffer_load_dwordx4 v9, s[40:43], s68 offen offset:1024  lds
    buffer_load_dwordx4 v10, s[40:43], s68 offen offset:2048  lds
    buffer_load_dwordx4 v10, s[40:43], s68 offen offset:3072  lds
L_kn_162:
    s_add_u32 s71, s71, 1
    s_add_u32 s58, s71, s62
    s_and_b32 s59, s71, 28
    s_lshr_b32 s59, s73, s59
    s_and_b32 s59, s59, 7
    s_and_b32 s58, s58, 3
    s_lshl2_add_u32 s58, s59, s58
    s_lshr_b32 s75, s58, 1
    s_cmp_eq_u32 s75, s74
    s_cbranch_scc1 L_kn_162
    s_mul_i32 s67, s58, 262144
    s_mul_i32 s68, s58, 131072
    s_add_u32 s69, s69, 32768
    s_cmp_ge_u32 s69, 98304
    s_cselect_b32 s58, 98304, 0
    s_sub_u32 s69, s69, s58
    s_cmp_lg_u32 s70, 0
    s_cbranch_scc1 L_no_165
    s_bitcmp1_b32 s78, s75
    s_cbranch_scc1 L_ns_163
    s_branch L_nf_166
L_nr_164:
    s_bitcmp1_b32 s78, s75
    s_cbranch_scc1 L_ns_163
    s_sub_u32 s80, s80, 1
    s_cbranch_scc1 L_ns_163
    s_sleep 2
L_nf_166:
    buffer_load_dword v18, v17, s[24:27], 0 offen sc1
    s_waitcnt vmcnt(0)
    v_cmp_eq_u32 s[78:79], s31, v18
    s_branch L_nr_164
L_ns_163:
    s_mov_b64 exec, 1
    ds_add_u32 v15, v16 offset:8
    s_mov_b64 exec, -1
    s_branch L_ne_167
L_no_165:
L_lw_168:
    ds_read_b32 v18, v15 offset:8
    s_waitcnt lgkmcnt(0)
    v_readfirstlane_b32 s58, v18
    s_cmp_lt_u32 s58, 2
    s_cbranch_scc1 L_lw_168
L_ne_167:
    s_mov_b32 m0, s69
    s_nop 0
    buffer_load_dwordx4 v5, s[36:39], s67 offen offset:0  lds
    buffer_load_dwordx4 v6, s[36:39], s67 offen offset:1024  lds
    buffer_load_dwordx4 v7, s[36:39], s67 offen offset:2048  lds
    buffer_load_dwordx4 v8, s[36:39], s67 offen offset:3072  lds
    s_add_u32 m0, s69, 16384
    s_nop 0
    buffer_load_dwordx4 v9, s[40:43], s68 offen offset:0  lds
    buffer_load_dwordx4 v9, s[40:43], s68 offen offset:1024  lds
    buffer_load_dwordx4 v10, s[40:43], s68 offen offset:2048  lds
    buffer_load_dwordx4 v10, s[40:43], s68 offen offset:3072  lds
L_kn_169:
    s_add_u32 s71, s71, 1
    s_add_u32 s58, s71, s62
    s_and_b32 s59, s71, 28
    s_lshr_b32 s59, s73, s59
    s_and_b32 s59, s59, 7
    s_and_b32 s58, s58, 3
    s_lshl2_add_u32 s58, s59, s58
    s_lshr_b32 s75, s58, 1
    s_cmp_eq_u32 s75, s74
    s_cbranch_scc1 L_kn_169
    s_mul_i32 s67, s58, 262144
    s_mul_i32 s68, s58, 131072
    s_add_u32 s69, s69, 32768
    s_cmp_ge_u32 s69, 98304
    s_cselect_b32 s58, 98304, 0
    s_sub_u32 s69, s69, s58
    s_waitcnt vmcnt(8)
    s_barrier
    s_branch L_f1_49
L_fc_152:
    s_and_b32 s60, s28, 1
    s_bfe_u32 s61, s28, 0x10001
    v_bfe_u32 v2, v1, 2, 2
    v_lshrrev_b32 v3, 5, v1
    v_lshl_add_u32 v3, v3, 3, v2
    v_lshlrev_b32 v104, 8, v3
    v_bfe_u32 v3, v1, 4, 1
    v_bfe_u32 v4, v1, 1, 1
    v_lshl_add_u32 v3, v3, 1, v4
    s_lshl_b32 s58, s60, 3
    v_add_u32 v3, s58, v3
    v_lshlrev_b32 v2, 2, v2
    v_xor_b32 v3, v3, v2
    v_and_b32 v4, 1, v1
    v_lshlrev_b32 v4, 3, v4
    v_add_u32 v104, v104, v4
    v_xor_b32 v2, 4, v3
    v_lshl_add_u32 v105, v2, 4, v104
    v_lshl_add_u32 v104, v3, 4, v104
    v_lshrrev_b32 v3, 5, v1
    v_lshlrev_b32 v3, 11, v3
    v_and_b32 v2, 31, v1
    v_lshl_add_u32 v3, v2, 4, v3
    s_lshl_b32 s58, s61, 10
    s_add_u32 s58, s58, 16384
    v_add_u32 v106, s58, v3
    s_mov_b32 s67, 65536
    v_add_u32 v107, s67, v104
    v_add_u32 v108, s67, v105
    v_add_u32 v109, s67, v106
    s_and_b32 s58, s29, 1
    s_lshl_b32 s58, s58, 2
    s_and_b32 s57, s30, 3
    s_add_u32 s57, s57, s58
    s_lshl_b32 s57, s57, 11
    s_bfe_u32 s63, s2, 0x10002
    s_bfe_u32 s58, s2, 0x10001
    s_lshl_b32 s58, s58, 3
    s_lshr_b32 s56, s30, 2
    s_add_u32 s56, s56, s58
    s_lshl_b32 s56, s56, 8
    s_mov_b32 s52, s10
    s_mov_b32 s53, s11
    s_mov_b32 s54, 0x1000
    s_mov_b32 s55, 0x00020000
    v_and_b32 v176, 31, v1
    s_lshl_b32 s58, s60, 7
    s_add_u32 s58, s58, s56
    v_lshl_add_u32 v176, v176, 1, s58
    s_lshl_b32 s70, s63, 6
    buffer_load_ushort v176, v176, s[52:55], s70 offen
    s_mov_b32 s36, s20
    s_mov_b32 s37, s21
    s_mov_b32 s38, 0x400000
    s_mov_b32 s39, 0x00020000
    s_add_u32 s40, s18, 0x3000000
    s_addc_u32 s41, s19, 0
    s_mov_b32 s42, 0x800000
    s_mov_b32 s43, 0x00020000
    v_and_b32 v2, 31, v1
    v_lshlrev_b32 v112, 11, v2
    v_lshrrev_b32 v2, 5, v1
    v_lshl_add_u32 v112, v2, 4, v112
    s_lshl_b32 s58, s56, 10
    v_add_u32 v112, s58, v112
    s_lshl_b32 s58, s60, 17
    v_add_u32 v112, s58, v112
    s_lshr_b32 s58, s57, 3
    v_add_u32 v112, s58, v112
    s_mul_i32 s58, s61, 128
    v_add_u32 v112, s58, v112
    v_and_b32 v2, 31, v1
    s_lshl_b32 s58, s60, 13
    s_add_u32 s58, s58, 98304
    v_lshl_add_u32 v3, v2, 8, s58
    v_lshrrev_b32 v4, 5, v1
    v_lshl_add_u32 v3, v4, 3, v3
    v_and_b32 v2, 15, v1
    s_lshl_b32 s58, s61, 3
    v_xor_b32 v2, s58, v2
    v_lshl_add_u32 v3, v2, 4, v3
    v_xor_b32 v115, 0, v3
    v_xor_b32 v116, 16, v3
    v_xor_b32 v117, 32, v3
    v_xor_b32 v118, 48, v3
    v_xor_b32 v119, 64, v3
    v_xor_b32 v120, 80, v3
    v_xor_b32 v121, 96, v3
    v_xor_b32 v122, 112, v3
    s_lshl_b32 s59, s63, 16
    v_lshlrev_b32 v113, 4, v1
    s_lshl_b32 s69, s2, 2
    s_add_u32 s69, s69, s28
    s_lshl_b32 s58, s69, 7
    v_mov_b32 v114, s58
    s_lshl_b32 s69, s69, 13
    s_add_u32 s70, s69, 4096
    v_mov_b32 v3, 1
    s_barrier
    s_branch L_seamC_5
gf_kernel_end:
.section .rodata,"a"
.p2align 6
.amdhsa_kernel gf_kernel
.amdhsa_next_free_vgpr 256
.amdhsa_next_free_sgpr 102
.amdhsa_accum_offset 256
.amdhsa_group_segment_fixed_size 0
.amdhsa_kernarg_size 88
.amdhsa_user_sgpr_count 2
.amdhsa_user_sgpr_kernarg_segment_ptr 1
.amdhsa_system_sgpr_workgroup_id_x 1
.amdhsa_float_denorm_mode_32 3
.end_amdhsa_kernel
```
